```python
import torch

def _softmax(x, axis=-1):
    return torch.softmax(x, dim=axis)
def _gelu(x):
    return torch.nn.functional.gelu(x, approximate="tanh")
def _silu(x):
    return torch.nn.functional.silu(x)
def _sigmoid(x):
    return torch.sigmoid(x)
def _layernorm(x, axis=-1, eps=1e-5):
    m = x.mean(dim=axis, keepdim=True)
    v = x.var(dim=axis, keepdim=True, unbiased=False)
    return (x - m) / torch.sqrt(v + eps)
def _scatter_add(tgt, idx, src, axis=0):
    return tgt.clone().index_add_(axis, idx, src)
def _segment_sum(src, seg, n):
    out = torch.zeros((n,) + src.shape[1:], dtype=src.dtype)
    return out.index_add_(0, seg, src)
def _pad(x, pw):
    flat = tuple(v for pair in reversed(pw) for v in pair)
    return torch.nn.functional.pad(x, flat)

kernel_name = 'standalone__fused_io_aware_attn__prompt'

def setup_inputs():

    _w = (lambda a: (lambda t: t.to(torch.bfloat16) if t.is_floating_point() else t)(torch.as_tensor(a)))
    B, H, S = 1, 32, 2048
    Dh = max(1, 512 // 32)
    return {
        "q": _w((lambda *s: torch.randn(*s, dtype=torch.bfloat16) * 0.8)(B, H, S, Dh)),
        "k": _w((lambda *s: torch.randn(*s, dtype=torch.bfloat16) * 0.8)(B, H, S, Dh)),
        "v": _w((lambda *s: torch.randn(*s, dtype=torch.bfloat16) * 0.05)(B, H, S, Dh)),
    }

def reference(q, k, v):
    scale = q.shape[-1] ** -0.5
    s = torch.einsum('bhqd,bhkd->bhqk', q, k) * scale
    p = _softmax(s, axis=-1)
    return torch.einsum('bhqk,bhkd->bhqd', p, v)
```

```asm
; @launch grid=(256,1,1) block=(512,1,1) lds=163088
.amdgcn_target "amdgcn-amd-amdhsa--gfx950"
.text
.globl standalone__fused_io_aware_attn__prompt_kernel
.p2align 8
.type standalone__fused_io_aware_attn__prompt_kernel,@function
standalone__fused_io_aware_attn__prompt_kernel:
    s_cmp_ge_u32 s2, 256
    s_cbranch_scc1 L_end
    s_load_dwordx4 s[36:39], s[0:1], 0
    s_load_dwordx4 s[40:43], s[0:1], 16
    s_getpc_b64 s[4:5]
L_pc:
    v_lshlrev_b32 v172, 5, v0
    v_min_u32 v172, L_fallback-L_pc, v172
    v_add_co_u32 v172, vcc, s4, v172
    v_mov_b32 v173, s5
    v_lshrrev_b32 v1, 6, v0
    v_addc_co_u32 v173, vcc, 0, v173, vcc
    global_load_dword v174, v[172:173], off
    s_setprio 3
    v_and_b32 v159, 63, v0
    v_readfirstlane_b32 s24, v1
    v_and_b32 v156, 31, v0
    v_lshlrev_b32 v156, 5, v156
    v_bfe_u32 v158, v0, 5, 1
    v_lshl_add_u32 v2, v158, 4, v156
    v_lshlrev_b32 v190, 4, v159
    s_and_b32 s33, s2, 7
    s_lshl_b32 s33, s33, 2
    s_lshr_b32 s34, s2, 6
    s_add_u32 s33, s33, s34
    s_lshl_b32 s25, s33, 16
    s_lshr_b32 s34, s2, 3
    s_and_b32 s34, s34, 7
    s_lshl_b32 s34, s34, 13
    s_and_b32 s44, s24, 3
    s_lshr_b32 s45, s24, 2
    s_lshl_b32 s35, s44, 11
    s_add_u32 s26, s25, s34
    s_add_u32 s26, s26, s35
    s_lshl_b32 s35, s45, 10
    s_add_u32 s26, s26, s35
    s_add_u32 s33, s24, 2
    s_bitcmp0_b32 s24, 0
    s_cselect_b32 s33, s33, s24
    s_bfe_u32 s33, s33, 0x20001
    s_lshl_b32 s7, s33, 10
    s_mul_i32 s35, s33, 1040
    s_add_u32 s35, s35, 65552
    s_bitcmp0_b32 s24, 0
    s_cselect_b32 s34, s7, s35
    s_cselect_b32 s29, 0, 32
    s_cselect_b64 vcc, -1, 0
    s_mov_b32 m0, s34
    s_add_u32 s29, s29, 2048
    v_cndmask_b32 v8, v190, v2, vcc
    s_mov_b32 s10, 2097152
    s_mov_b32 s11, 0x00020000
    s_mov_b32 s14, 65536
    s_mov_b32 s15, 0x00020000
    s_mov_b32 s22, 65536
    s_mov_b32 s23, 0x00020000
    s_bitcmp0_b32 s24, 0
    s_waitcnt lgkmcnt(0)
    s_cselect_b32 s12, s38, s40
    s_cselect_b32 s13, s39, s41
    s_mov_b32 s8, s36
    s_mov_b32 s9, s37
    s_add_u32 s12, s12, s25
    s_addc_u32 s13, s13, 0
    s_add_u32 s20, s38, s25
    s_addc_u32 s21, s39, 0
    buffer_load_dwordx4 v8, s[12:15], s7 offen lds
    buffer_load_dwordx4 v[148:151], v2, s[8:11], s26 offen
    buffer_load_dwordx4 v[152:155], v2, s[20:23], 0 offen
    s_mov_b32 s16, s42
    s_mov_b32 s17, s43
    s_mov_b32 s18, 2097152
    s_mov_b32 s19, 0x00020000
    s_mov_b32 s30, 0x3eb8aa3b
    s_mov_b32 s31, 0
    s_mul_i32 s33, s45, 28
    s_lshr_b32 s34, s44, 1
    s_add_u32 s33, s33, s34
    s_add_u32 s33, s33, 4
    s_lshl_b32 s27, s33, 10
    s_mul_i32 s35, s33, 1040
    s_add_u32 s35, s35, 65552
    s_bitcmp0_b32 s24, 0
    s_cselect_b32 s28, s27, s35
    v_and_b32 v156, 1, v1
    v_add_u32 v156, v156, v159
    v_mul_u32_u24 v156, 1040, v156
    v_add_u32 v156, 65536, v156
    v_mov_b32 v16, 0x00003f80
    v_mov_b32 v17, 0
    v_mov_b32 v18, 0
    v_mov_b32 v19, 0
    ds_write_b128 v156, v[16:19]
    v_lshlrev_b32 v157, 2, v159
    v_add_u32 v157, 162832, v157
    ds_write_b32 v157, v17
    s_waitcnt lgkmcnt(0)
    s_barrier
    s_mov_b32 m0, s28
    s_nop 0
    buffer_load_dwordx4 v8, s[12:15], s27 offen lds
    s_add_u32 m0, m0, s29
    s_add_u32 s27, s27, 2048
    buffer_load_dwordx4 v8, s[12:15], s27 offen lds
    v_mov_b32 v13, 1
    v_mov_b32 v182, 162832
    v_mov_b32 v200, 162832
    s_lshl_b32 s33, s45, 5
    s_add_u32 s33, s33, 162864
    v_mov_b32 v10, s33
    s_lshl_b32 s33, s44, 4
    s_add_u32 s33, s33, 162960
    v_mov_b32 v11, s33
    s_mul_i32 s33, s44, 4608
    s_add_u32 s33, s33, 144400
    s_mul_i32 s34, s45, 2304
    s_sub_u32 s35, 2304, s34
    s_add_u32 s34, s34, s33
    s_add_u32 s35, s35, s33
    v_add_u32 v9, s34, v190
    v_add_u32 v196, s35, v190
    v_lshlrev_b32 v156, 2, v159
    v_add_u32 v1, s34, v156
    v_add_u32 v197, s35, v156
    s_mul_i32 s33, s44, 3072
    s_add_u32 s33, s33, 132112
    v_add_u32 v15, s33, v190
    s_lshl_b32 s34, s45, 10
    s_xor_b32 s35, s34, 1024
    v_add_u32 v176, s34, v15
    v_add_u32 v177, s35, v15
    s_lshl_b32 s34, s45, 3
    s_add_u32 s34, s34, 2048
    s_xor_b32 s35, s34, 8
    v_add_u32 v178, s34, v15
    v_add_u32 v179, s35, v15
    s_lshl_b32 s34, s45, 2
    s_xor_b32 s35, s34, 4
    v_add_u32 v180, s34, v11
    v_add_u32 v181, s35, v11
    v_mov_b32 v198, v180
    v_mov_b32 v199, v181
    v_and_b32 v156, 15, v0
    v_lshlrev_b32 v156, 3, v156
    v_lshl_add_u32 v156, v158, 8, v156
    v_add_u32 v156, 65552, v156
    v_and_b32 v160, 2, v0
    v_lshlrev_b32 v157, 2, v160
    v_add_u32 v157, 65536, v157
    v_add_u32 v163, 1040, v157
    v_and_b32 v160, 16, v0
    v_cmp_eq_u32 vcc, 0, v160
    v_add_u32 v160, 128, v156
    v_add_u32 v161, 512, v156
    v_add_u32 v162, 640, v156
    v_cndmask_b32 v191, v157, v156, vcc
    v_cndmask_b32 v192, v163, v160, vcc
    v_cndmask_b32 v193, v157, v161, vcc
    v_cndmask_b32 v194, v163, v162, vcc
    v_mov_b32 v195, 0xdddddddd
    v_mov_b32 v64, 0
    v_mov_b32 v65, 0
    v_mov_b32 v66, 0
    v_mov_b32 v67, 0
    v_mov_b32 v68, 0
    v_mov_b32 v69, 0
    v_mov_b32 v70, 0
    v_mov_b32 v71, 0
    v_mov_b32 v72, 0
    v_mov_b32 v73, 0
    v_mov_b32 v74, 0
    v_mov_b32 v75, 0
    v_mov_b32 v76, 0
    v_mov_b32 v77, 0
    v_mov_b32 v78, 0
    v_mov_b32 v79, 0
    v_mov_b32 v80, 0
    v_mov_b32 v81, 0
    v_mov_b32 v82, 0
    v_mov_b32 v83, 0
    v_mov_b32 v84, 0
    v_mov_b32 v85, 0
    v_mov_b32 v86, 0
    v_mov_b32 v87, 0
    v_mov_b32 v88, 0
    v_mov_b32 v89, 0
    v_mov_b32 v90, 0
    v_mov_b32 v91, 0
    v_mov_b32 v92, 0
    v_mov_b32 v93, 0
    v_mov_b32 v94, 0
    v_mov_b32 v95, 0
    s_mul_i32 s33, s45, 29120
    s_mul_i32 s34, s45, 28672
    v_add_u32 v4, s33, v191
    v_add_u32 v5, s33, v192
    v_add_u32 v6, s33, v193
    v_add_u32 v7, s33, v194
    v_add_u32 v3, s34, v190
    s_mov_b32 s33, 0x5d800000
    s_mov_b32 s34, 0x21800000
    s_mov_b32 s35, 0x7b800000
    s_waitcnt vmcnt(4)
    s_mov_b64 exec, 1
    ds_add_u32 v10, v13 offset:0
    s_mov_b64 exec, -1
    s_waitcnt vmcnt(3)
    v_lshlrev_b32 v156, 16, v148
    v_and_b32 v157, 0xffff0000, v148
    v_mul_f32 v156, s30, v156
    v_mul_f32 v157, s30, v157
    v_cvt_pk_bf16_f32 v128, v156, v157
    v_lshlrev_b32 v158, 16, v149
    v_and_b32 v159, 0xffff0000, v149
    v_mul_f32 v158, s30, v158
    v_mul_f32 v159, s30, v159
    v_cvt_pk_bf16_f32 v129, v158, v159
    v_lshlrev_b32 v156, 16, v150
    v_and_b32 v157, 0xffff0000, v150
    v_mul_f32 v156, s30, v156
    v_mul_f32 v157, s30, v157
    v_cvt_pk_bf16_f32 v130, v156, v157
    v_lshlrev_b32 v158, 16, v151
    v_and_b32 v159, 0xffff0000, v151
    v_mul_f32 v158, s30, v158
    v_mul_f32 v159, s30, v159
    v_cvt_pk_bf16_f32 v131, v158, v159
    s_waitcnt vmcnt(2)
    ds_write_b128 v176, v[128:131]
    v_mfma_f32_32x32x16_bf16 v[16:31], v[152:155], v[128:131], 0
    s_nop 11
    v_max3_f32 v160, v16, v17, v18
    v_max3_f32 v161, v19, v20, v21
    v_max3_f32 v162, v22, v23, v24
    v_max3_f32 v163, v25, v26, v27
    v_max3_f32 v164, v28, v29, v30
    v_max3_f32 v160, v160, v161, v31
    v_max3_f32 v162, v162, v163, v164
    v_max_f32 v160, v160, v162
    v_mov_b32 v161, v160
    s_nop 1
    v_permlane32_swap_b32 v160, v161
    s_nop 1
    v_max_f32 v160, v160, v161
L_go:
    v_sub_f32 v156, 0, v160
    v_sub_f32 v157, 0, v160
    ds_write_b64 v178, v[156:157]
    ds_read2_b64 v[96:99], v178 offset0:0 offset1:0
    ds_read2_b64 v[100:103], v178 offset0:0 offset1:0
    ds_read2_b64 v[104:107], v178 offset0:0 offset1:0
    ds_read2_b64 v[108:111], v178 offset0:0 offset1:0
    s_mov_b64 exec, 1
    ds_add_u32 v180, v13 offset:0
    s_mov_b64 exec, -1
    v_sub_f32 v16, v16, v160
    v_sub_f32 v17, v17, v160
    v_sub_f32 v18, v18, v160
    v_sub_f32 v19, v19, v160
    v_sub_f32 v20, v20, v160
    v_sub_f32 v21, v21, v160
    v_sub_f32 v22, v22, v160
    v_sub_f32 v23, v23, v160
    v_exp_f32 v16, v16
    v_exp_f32 v17, v17
    v_exp_f32 v18, v18
    v_exp_f32 v19, v19
    ds_read_b32 v12, v182 offset:32
    v_sub_f32 v24, v24, v160
    v_sub_f32 v25, v25, v160
    v_sub_f32 v26, v26, v160
    v_sub_f32 v27, v27, v160
    v_sub_f32 v28, v28, v160
    v_sub_f32 v29, v29, v160
    v_sub_f32 v30, v30, v160
    v_sub_f32 v31, v31, v160
    v_exp_f32 v20, v20
    v_exp_f32 v21, v21
    v_exp_f32 v22, v22
    v_exp_f32 v23, v23
    v_exp_f32 v24, v24
    v_exp_f32 v25, v25
    s_waitcnt lgkmcnt(0)
    v_cmp_ne_u32 vcc, 4, v12
    s_cbranch_vccz L_g0ok
L_p0:
    ds_read_b32 v12, v182 offset:32
    s_waitcnt lgkmcnt(0)
    v_cmp_ne_u32 vcc, 4, v12
    s_cbranch_vccnz L_p0
L_g0ok:
    ds_read_b128 v[136:139], v190 offset:1024
    ds_read_b64_tr_b16 v[140:141], v191 offset:0
    ds_read_b64_tr_b16 v[142:143], v192 offset:0
    ds_read_b64_tr_b16 v[144:145], v193 offset:0
    ds_read_b64_tr_b16 v[146:147], v194 offset:0
    v_exp_f32 v26, v26
    v_exp_f32 v27, v27
    v_exp_f32 v28, v28
    v_exp_f32 v29, v29
    v_exp_f32 v30, v30
    v_exp_f32 v31, v31
    s_waitcnt lgkmcnt(4)
    v_mfma_f32_32x32x16_bf16 v[32:47], v[136:139], v[128:131], v[96:111]
    ds_read_b128 v[136:139], v190 offset:2048
    s_waitcnt lgkmcnt(3)
    v_smfmac_f32_32x32x32_bf16 v[64:79], v[140:143], v[16:23], v195
    ds_read_b32 v14, v182 offset:64
    ds_read_b64_tr_b16 v[140:141], v191 offset:1040
    ds_read_b64_tr_b16 v[142:143], v192 offset:1040
    s_waitcnt vmcnt(1)
    s_mov_b64 exec, 1
    ds_add_u32 v10, v13 offset:4
    s_mov_b64 exec, -1
L_join:
    s_waitcnt lgkmcnt(4)
    v_mfma_f32_32x32x16_bf16 v[48:63], v[136:139], v[128:131], v[96:111]
    s_waitcnt lgkmcnt(3)
    v_cmp_ne_u32 vcc, 4, v14
    s_cbranch_vccnz L_wf1
L_rf1:
    ds_read_b128 v[136:139], v190 offset:3072
    s_nop 1
    v_exp_f32 v32, v32
    v_exp_f32 v33, v33
    v_exp_f32 v34, v34
    v_exp_f32 v35, v35
    v_exp_f32 v36, v36
    v_smfmac_f32_32x32x32_bf16 v[64:79], v[144:147], v[24:31], v195
    ds_read_b64_tr_b16 v[144:145], v193 offset:1040
    ds_read_b64_tr_b16 v[146:147], v194 offset:1040
    ds_read_b32 v12, v10 offset:4
    v_exp_f32 v37, v37
    v_exp_f32 v38, v38
    v_exp_f32 v39, v39
    v_exp_f32 v40, v40
    v_exp_f32 v41, v41
    v_exp_f32 v42, v42
    s_waitcnt lgkmcnt(5)
    v_smfmac_f32_32x32x32_bf16 v[64:79], v[140:143], v[32:39], v195
    ds_read_b64_tr_b16 v[140:141], v191 offset:2080
    ds_read_b64_tr_b16 v[142:143], v192 offset:2080
    s_add_u32 m0, m0, s29
    s_add_u32 s27, s27, 2048
    buffer_load_dwordx4 v8, s[12:15], s27 offen lds
    v_exp_f32 v43, v43
    v_exp_f32 v44, v44
    v_exp_f32 v45, v45
    v_exp_f32 v46, v46
    v_exp_f32 v47, v47
    s_waitcnt lgkmcnt(5)
    v_mfma_f32_32x32x16_bf16 v[16:31], v[136:139], v[128:131], v[96:111]
    s_waitcnt lgkmcnt(2)
    v_cmp_ne_u32 vcc, 4, v12
    s_cbranch_vccnz L_wg1
L_rg1:
    ds_read_b128 v[136:139], v3 offset:4096
    v_exp_f32 v48, v48
    v_exp_f32 v49, v49
    v_exp_f32 v50, v50
    v_exp_f32 v51, v51
    v_exp_f32 v52, v52
    v_smfmac_f32_32x32x32_bf16 v[64:79], v[144:147], v[40:47], v195
    ds_read_b64_tr_b16 v[144:145], v193 offset:2080
    ds_read_b64_tr_b16 v[146:147], v194 offset:2080
    ds_read_b32 v14, v181
    v_exp_f32 v53, v53
    v_exp_f32 v54, v54
    v_exp_f32 v55, v55
    v_exp_f32 v56, v56
    v_exp_f32 v57, v57
    v_exp_f32 v58, v58
    s_waitcnt lgkmcnt(4)
    v_smfmac_f32_32x32x32_bf16 v[64:79], v[140:143], v[48:55], v195
    ds_read_b64_tr_b16 v[140:141], v191 offset:3120
    ds_read_b64_tr_b16 v[142:143], v192 offset:3120
    v_exp_f32 v59, v59
    v_exp_f32 v60, v60
    v_exp_f32 v61, v61
    v_exp_f32 v62, v62
    v_exp_f32 v63, v63
    s_waitcnt lgkmcnt(5)
    v_mfma_f32_32x32x16_bf16 v[32:47], v[136:139], v[128:131], v[96:111]
    s_waitcnt lgkmcnt(2)
    v_cmp_ne_u32 vcc, 1, v14
    s_cbranch_vccnz L_wxp
L_rxp:
    ds_read_b128 v[132:135], v177
    ds_read2_b64 v[112:115], v179 offset0:0 offset1:0
    ds_read2_b64 v[116:119], v179 offset0:0 offset1:0
    ds_read2_b64 v[120:123], v179 offset0:0 offset1:0
    ds_read2_b64 v[124:127], v179 offset0:0 offset1:0
    v_exp_f32 v16, v16
    v_exp_f32 v17, v17
    v_exp_f32 v18, v18
    v_exp_f32 v19, v19
    v_exp_f32 v20, v20
    v_smfmac_f32_32x32x32_bf16 v[64:79], v[144:147], v[56:63], v195
    ds_read_b64_tr_b16 v[144:145], v193 offset:3120
    ds_read_b64_tr_b16 v[146:147], v194 offset:3120
    v_exp_f32 v21, v21
    v_exp_f32 v22, v22
    v_exp_f32 v23, v23
    v_exp_f32 v24, v24
    v_exp_f32 v25, v25
    v_exp_f32 v26, v26
    s_waitcnt lgkmcnt(7)
    v_smfmac_f32_32x32x32_bf16 v[64:79], v[140:143], v[16:23], v195
    ds_read_b64_tr_b16 v[140:141], v4 offset:4160
    ds_read_b64_tr_b16 v[142:143], v5 offset:4160
    s_waitcnt vmcnt(1)
    s_mov_b64 exec, 1
    ds_add_u32 v10, v13 offset:8
    s_mov_b64 exec, -1
    s_add_u32 m0, m0, s29
    s_add_u32 s27, s27, 2048
    buffer_load_dwordx4 v8, s[12:15], s27 offen lds
    v_exp_f32 v27, v27
    v_exp_f32 v28, v28
    v_exp_f32 v29, v29
    v_exp_f32 v30, v30
    v_exp_f32 v31, v31
    s_waitcnt lgkmcnt(5)
    v_mfma_f32_32x32x16_bf16 v[48:63], v[136:139], v[132:135], v[112:127]
    ds_read_b128 v[136:139], v3 offset:5120
    v_exp_f32 v32, v32
    v_exp_f32 v33, v33
    v_exp_f32 v34, v34
    v_exp_f32 v35, v35
    v_exp_f32 v36, v36
    s_waitcnt lgkmcnt(4)
    v_smfmac_f32_32x32x32_bf16 v[64:79], v[144:147], v[24:31], v195
    ds_read_b64_tr_b16 v[144:145], v6 offset:4160
    ds_read_b64_tr_b16 v[146:147], v7 offset:4160
    v_exp_f32 v37, v37
    v_exp_f32 v38, v38
    v_exp_f32 v39, v39
    v_exp_f32 v40, v40
    v_exp_f32 v41, v41
    v_exp_f32 v42, v42
    s_waitcnt lgkmcnt(4)
    v_smfmac_f32_32x32x32_bf16 v[64:79], v[140:143], v[32:39], v195
    v_exp_f32 v43, v43
    v_exp_f32 v44, v44
    v_exp_f32 v45, v45
    v_exp_f32 v46, v46
    v_exp_f32 v47, v47
    s_waitcnt lgkmcnt(0)
    v_mfma_f32_32x32x16_bf16 v[16:31], v[136:139], v[128:131], v[96:111]
    v_exp_f32 v48, v48
    v_exp_f32 v49, v49
    v_exp_f32 v50, v50
    v_exp_f32 v51, v51
    v_exp_f32 v52, v52
    v_smfmac_f32_32x32x32_bf16 v[64:79], v[144:147], v[40:47], v195
    ds_read_b32 v12, v10 offset:8
    v_exp_f32 v53, v53
    v_exp_f32 v54, v54
    v_exp_f32 v55, v55
    v_exp_f32 v56, v56
    v_exp_f32 v57, v57
    v_exp_f32 v58, v58
    v_smfmac_f32_32x32x32_bf16 v[80:95], v[140:143], v[48:55], v195
    ds_read_b64_tr_b16 v[140:141], v4 offset:5200
    ds_read_b64_tr_b16 v[142:143], v5 offset:5200
    s_add_u32 m0, m0, s29
    s_add_u32 s27, s27, 2048
    buffer_load_dwordx4 v8, s[12:15], s27 offen lds
    v_exp_f32 v59, v59
    v_exp_f32 v60, v60
    v_exp_f32 v61, v61
    v_exp_f32 v62, v62
    v_exp_f32 v63, v63
    v_mfma_f32_32x32x16_bf16 v[32:47], v[136:139], v[132:135], v[112:127]
    s_waitcnt lgkmcnt(2)
    v_cmp_ne_u32 vcc, 4, v12
    s_cbranch_vccnz L_wg2
L_rg2:
    ds_read_b128 v[136:139], v3 offset:6144
    v_exp_f32 v16, v16
    v_exp_f32 v17, v17
    v_exp_f32 v18, v18
    v_exp_f32 v19, v19
    v_exp_f32 v20, v20
    v_smfmac_f32_32x32x32_bf16 v[80:95], v[144:147], v[56:63], v195
    ds_read_b64_tr_b16 v[144:145], v6 offset:5200
    ds_read_b64_tr_b16 v[146:147], v7 offset:5200
    v_exp_f32 v21, v21
    v_exp_f32 v22, v22
    v_exp_f32 v23, v23
    v_exp_f32 v24, v24
    v_exp_f32 v25, v25
    v_exp_f32 v26, v26
    s_waitcnt lgkmcnt(3)
    v_smfmac_f32_32x32x32_bf16 v[64:79], v[140:143], v[16:23], v195
    v_exp_f32 v27, v27
    v_exp_f32 v28, v28
    v_exp_f32 v29, v29
    v_exp_f32 v30, v30
    v_exp_f32 v31, v31
    s_waitcnt lgkmcnt(0)
    v_mfma_f32_32x32x16_bf16 v[48:63], v[136:139], v[128:131], v[96:111]
    v_exp_f32 v32, v32
    v_exp_f32 v33, v33
    v_exp_f32 v34, v34
    v_exp_f32 v35, v35
    v_exp_f32 v36, v36
    v_smfmac_f32_32x32x32_bf16 v[64:79], v[144:147], v[24:31], v195
    v_exp_f32 v37, v37
    v_exp_f32 v38, v38
    v_exp_f32 v39, v39
    v_exp_f32 v40, v40
    v_exp_f32 v41, v41
    v_exp_f32 v42, v42
    v_smfmac_f32_32x32x32_bf16 v[80:95], v[140:143], v[32:39], v195
    ds_read_b64_tr_b16 v[140:141], v4 offset:6240
    ds_read_b64_tr_b16 v[142:143], v5 offset:6240
    s_add_u32 m0, m0, s29
    s_add_u32 s27, s27, 2048
    buffer_load_dwordx4 v8, s[12:15], s27 offen lds
    v_exp_f32 v43, v43
    v_exp_f32 v44, v44
    v_exp_f32 v45, v45
    v_exp_f32 v46, v46
    v_exp_f32 v47, v47
    v_mfma_f32_32x32x16_bf16 v[16:31], v[136:139], v[132:135], v[112:127]
    ds_read_b128 v[136:139], v3 offset:7168
    v_exp_f32 v48, v48
    v_exp_f32 v49, v49
    v_exp_f32 v50, v50
    v_exp_f32 v51, v51
    v_exp_f32 v52, v52
    v_smfmac_f32_32x32x32_bf16 v[80:95], v[144:147], v[40:47], v195
    ds_read_b64_tr_b16 v[144:145], v6 offset:6240
    ds_read_b64_tr_b16 v[146:147], v7 offset:6240
    v_exp_f32 v53, v53
    v_exp_f32 v54, v54
    v_exp_f32 v55, v55
    v_exp_f32 v56, v56
    v_exp_f32 v57, v57
    v_exp_f32 v58, v58
    s_waitcnt lgkmcnt(3)
    v_smfmac_f32_32x32x32_bf16 v[64:79], v[140:143], v[48:55], v195
    s_waitcnt vmcnt(2)
    s_mov_b64 exec, 1
    ds_add_u32 v10, v13 offset:12
    s_mov_b64 exec, -1
    v_exp_f32 v59, v59
    v_exp_f32 v60, v60
    v_exp_f32 v61, v61
    v_exp_f32 v62, v62
    v_exp_f32 v63, v63
    s_waitcnt lgkmcnt(1)
    v_mfma_f32_32x32x16_bf16 v[32:47], v[136:139], v[128:131], v[96:111]
    v_exp_f32 v16, v16
    v_exp_f32 v17, v17
    v_exp_f32 v18, v18
    v_exp_f32 v19, v19
    v_exp_f32 v20, v20
    v_smfmac_f32_32x32x32_bf16 v[64:79], v[144:147], v[56:63], v195
    ds_read_b32 v12, v10 offset:12
    v_exp_f32 v21, v21
    v_exp_f32 v22, v22
    v_exp_f32 v23, v23
    v_exp_f32 v24, v24
    v_exp_f32 v25, v25
    v_exp_f32 v26, v26
    v_smfmac_f32_32x32x32_bf16 v[80:95], v[140:143], v[16:23], v195
    ds_read_b64_tr_b16 v[140:141], v4 offset:7280
    ds_read_b64_tr_b16 v[142:143], v5 offset:7280
    s_add_u32 m0, m0, s29
    s_add_u32 s27, s27, 2048
    buffer_load_dwordx4 v8, s[12:15], s27 offen lds
    v_exp_f32 v27, v27
    v_exp_f32 v28, v28
    v_exp_f32 v29, v29
    v_exp_f32 v30, v30
    v_exp_f32 v31, v31
    v_mfma_f32_32x32x16_bf16 v[48:63], v[136:139], v[132:135], v[112:127]
    s_waitcnt lgkmcnt(2)
    v_cmp_ne_u32 vcc, 4, v12
    s_cbranch_vccnz L_wg3
L_rg3:
    ds_read_b128 v[136:139], v3 offset:8192
    v_exp_f32 v32, v32
    v_exp_f32 v33, v33
    v_exp_f32 v34, v34
    v_exp_f32 v35, v35
    v_exp_f32 v36, v36
    v_smfmac_f32_32x32x32_bf16 v[80:95], v[144:147], v[24:31], v195
    ds_read_b64_tr_b16 v[144:145], v6 offset:7280
    ds_read_b64_tr_b16 v[146:147], v7 offset:7280
    v_exp_f32 v37, v37
    v_exp_f32 v38, v38
    v_exp_f32 v39, v39
    v_exp_f32 v40, v40
    v_exp_f32 v41, v41
    v_exp_f32 v42, v42
    s_waitcnt lgkmcnt(3)
    v_smfmac_f32_32x32x32_bf16 v[64:79], v[140:143], v[32:39], v195
    v_exp_f32 v43, v43
    v_exp_f32 v44, v44
    v_exp_f32 v45, v45
    v_exp_f32 v46, v46
    v_exp_f32 v47, v47
    s_waitcnt lgkmcnt(0)
    v_mfma_f32_32x32x16_bf16 v[16:31], v[136:139], v[128:131], v[96:111]
    v_exp_f32 v48, v48
    v_exp_f32 v49, v49
    v_exp_f32 v50, v50
    v_exp_f32 v51, v51
    v_exp_f32 v52, v52
    v_smfmac_f32_32x32x32_bf16 v[64:79], v[144:147], v[40:47], v195
    v_exp_f32 v53, v53
    v_exp_f32 v54, v54
    v_exp_f32 v55, v55
    v_exp_f32 v56, v56
    v_exp_f32 v57, v57
    v_exp_f32 v58, v58
    v_smfmac_f32_32x32x32_bf16 v[80:95], v[140:143], v[48:55], v195
    ds_read_b64_tr_b16 v[140:141], v4 offset:8320
    ds_read_b64_tr_b16 v[142:143], v5 offset:8320
    s_add_u32 m0, m0, s29
    s_add_u32 s27, s27, 2048
    buffer_load_dwordx4 v8, s[12:15], s27 offen lds
    v_exp_f32 v59, v59
    v_exp_f32 v60, v60
    v_exp_f32 v61, v61
    v_exp_f32 v62, v62
    v_exp_f32 v63, v63
    v_mfma_f32_32x32x16_bf16 v[32:47], v[136:139], v[132:135], v[112:127]
    ds_read_b128 v[136:139], v3 offset:9216
    v_exp_f32 v16, v16
    v_exp_f32 v17, v17
    v_exp_f32 v18, v18
    v_exp_f32 v19, v19
    v_exp_f32 v20, v20
    v_smfmac_f32_32x32x32_bf16 v[80:95], v[144:147], v[56:63], v195
    ds_read_b64_tr_b16 v[144:145], v6 offset:8320
    ds_read_b64_tr_b16 v[146:147], v7 offset:8320
    v_exp_f32 v21, v21
    v_exp_f32 v22, v22
    v_exp_f32 v23, v23
    v_exp_f32 v24, v24
    v_exp_f32 v25, v25
    v_exp_f32 v26, v26
    s_waitcnt lgkmcnt(3)
    v_smfmac_f32_32x32x32_bf16 v[64:79], v[140:143], v[16:23], v195
    v_exp_f32 v27, v27
    v_exp_f32 v28, v28
    v_exp_f32 v29, v29
    v_exp_f32 v30, v30
    v_exp_f32 v31, v31
    s_waitcnt lgkmcnt(0)
    v_mfma_f32_32x32x16_bf16 v[48:63], v[136:139], v[128:131], v[96:111]
    v_exp_f32 v32, v32
    v_exp_f32 v33, v33
    v_exp_f32 v34, v34
    v_exp_f32 v35, v35
    v_exp_f32 v36, v36
    v_smfmac_f32_32x32x32_bf16 v[64:79], v[144:147], v[24:31], v195
    v_exp_f32 v37, v37
    v_exp_f32 v38, v38
    v_exp_f32 v39, v39
    v_exp_f32 v40, v40
    v_exp_f32 v41, v41
    v_exp_f32 v42, v42
    v_smfmac_f32_32x32x32_bf16 v[80:95], v[140:143], v[32:39], v195
    ds_read_b64_tr_b16 v[140:141], v4 offset:9360
    ds_read_b64_tr_b16 v[142:143], v5 offset:9360
    s_add_u32 m0, m0, s29
    s_add_u32 s27, s27, 2048
    buffer_load_dwordx4 v8, s[12:15], s27 offen lds
    v_exp_f32 v43, v43
    v_exp_f32 v44, v44
    v_exp_f32 v45, v45
    v_exp_f32 v46, v46
    v_exp_f32 v47, v47
    v_mfma_f32_32x32x16_bf16 v[16:31], v[136:139], v[132:135], v[112:127]
    ds_read_b128 v[136:139], v3 offset:10240
    v_exp_f32 v48, v48
    v_exp_f32 v49, v49
    v_exp_f32 v50, v50
    v_exp_f32 v51, v51
    v_exp_f32 v52, v52
    v_smfmac_f32_32x32x32_bf16 v[80:95], v[144:147], v[40:47], v195
    ds_read_b64_tr_b16 v[144:145], v6 offset:9360
    ds_read_b64_tr_b16 v[146:147], v7 offset:9360
    v_exp_f32 v53, v53
    v_exp_f32 v54, v54
    v_exp_f32 v55, v55
    v_exp_f32 v56, v56
    v_exp_f32 v57, v57
    v_exp_f32 v58, v58
    s_waitcnt lgkmcnt(3)
    v_smfmac_f32_32x32x32_bf16 v[64:79], v[140:143], v[48:55], v195
    v_exp_f32 v59, v59
    v_exp_f32 v60, v60
    v_exp_f32 v61, v61
    v_exp_f32 v62, v62
    v_exp_f32 v63, v63
    s_waitcnt lgkmcnt(0)
    v_mfma_f32_32x32x16_bf16 v[32:47], v[136:139], v[128:131], v[96:111]
    v_exp_f32 v16, v16
    v_exp_f32 v17, v17
    v_exp_f32 v18, v18
    v_exp_f32 v19, v19
    v_exp_f32 v20, v20
    v_smfmac_f32_32x32x32_bf16 v[64:79], v[144:147], v[56:63], v195
    v_exp_f32 v21, v21
    v_exp_f32 v22, v22
    v_exp_f32 v23, v23
    v_exp_f32 v24, v24
    v_exp_f32 v25, v25
    v_exp_f32 v26, v26
    v_smfmac_f32_32x32x32_bf16 v[80:95], v[140:143], v[16:23], v195
    ds_read_b64_tr_b16 v[140:141], v4 offset:10400
    ds_read_b64_tr_b16 v[142:143], v5 offset:10400
    s_add_u32 m0, m0, s29
    s_add_u32 s27, s27, 2048
    buffer_load_dwordx4 v8, s[12:15], s27 offen lds
    v_exp_f32 v27, v27
    v_exp_f32 v28, v28
    v_exp_f32 v29, v29
    v_exp_f32 v30, v30
    v_exp_f32 v31, v31
    v_mfma_f32_32x32x16_bf16 v[48:63], v[136:139], v[132:135], v[112:127]
    ds_read_b128 v[136:139], v3 offset:11264
    v_exp_f32 v32, v32
    v_exp_f32 v33, v33
    v_exp_f32 v34, v34
    v_exp_f32 v35, v35
    v_exp_f32 v36, v36
    v_smfmac_f32_32x32x32_bf16 v[80:95], v[144:147], v[24:31], v195
    ds_read_b64_tr_b16 v[144:145], v6 offset:10400
    ds_read_b64_tr_b16 v[146:147], v7 offset:10400
    v_exp_f32 v37, v37
    v_exp_f32 v38, v38
    v_exp_f32 v39, v39
    v_exp_f32 v40, v40
    v_exp_f32 v41, v41
    v_exp_f32 v42, v42
    s_waitcnt lgkmcnt(3)
    v_smfmac_f32_32x32x32_bf16 v[64:79], v[140:143], v[32:39], v195
    s_waitcnt vmcnt(2)
    s_mov_b64 exec, 1
    ds_add_u32 v10, v13 offset:16
    s_mov_b64 exec, -1
    v_exp_f32 v43, v43
    v_exp_f32 v44, v44
    v_exp_f32 v45, v45
    v_exp_f32 v46, v46
    v_exp_f32 v47, v47
    s_waitcnt lgkmcnt(1)
    v_mfma_f32_32x32x16_bf16 v[16:31], v[136:139], v[128:131], v[96:111]
    v_exp_f32 v48, v48
    v_exp_f32 v49, v49
    v_exp_f32 v50, v50
    v_exp_f32 v51, v51
    v_exp_f32 v52, v52
    v_smfmac_f32_32x32x32_bf16 v[64:79], v[144:147], v[40:47], v195
    ds_read_b32 v12, v10 offset:16
    v_exp_f32 v53, v53
    v_exp_f32 v54, v54
    v_exp_f32 v55, v55
    v_exp_f32 v56, v56
    v_exp_f32 v57, v57
    v_exp_f32 v58, v58
    v_smfmac_f32_32x32x32_bf16 v[80:95], v[140:143], v[48:55], v195
    ds_read_b64_tr_b16 v[140:141], v4 offset:11440
    ds_read_b64_tr_b16 v[142:143], v5 offset:11440
    s_add_u32 m0, m0, s29
    s_add_u32 s27, s27, 2048
    buffer_load_dwordx4 v8, s[12:15], s27 offen lds
    v_exp_f32 v59, v59
    v_exp_f32 v60, v60
    v_exp_f32 v61, v61
    v_exp_f32 v62, v62
    v_exp_f32 v63, v63
    v_mfma_f32_32x32x16_bf16 v[32:47], v[136:139], v[132:135], v[112:127]
    s_waitcnt lgkmcnt(2)
    v_cmp_ne_u32 vcc, 4, v12
    s_cbranch_vccnz L_wg4
L_rg4:
    ds_read_b128 v[136:139], v3 offset:12288
    v_exp_f32 v16, v16
    v_exp_f32 v17, v17
    v_exp_f32 v18, v18
    v_exp_f32 v19, v19
    v_exp_f32 v20, v20
    v_smfmac_f32_32x32x32_bf16 v[80:95], v[144:147], v[56:63], v195
    ds_read_b64_tr_b16 v[144:145], v6 offset:11440
    ds_read_b64_tr_b16 v[146:147], v7 offset:11440
    v_exp_f32 v21, v21
    v_exp_f32 v22, v22
    v_exp_f32 v23, v23
    v_exp_f32 v24, v24
    v_exp_f32 v25, v25
    v_exp_f32 v26, v26
    s_waitcnt lgkmcnt(3)
    v_smfmac_f32_32x32x32_bf16 v[64:79], v[140:143], v[16:23], v195
    v_exp_f32 v27, v27
    v_exp_f32 v28, v28
    v_exp_f32 v29, v29
    v_exp_f32 v30, v30
    v_exp_f32 v31, v31
    s_waitcnt lgkmcnt(0)
    v_mfma_f32_32x32x16_bf16 v[48:63], v[136:139], v[128:131], v[96:111]
    v_exp_f32 v32, v32
    v_exp_f32 v33, v33
    v_exp_f32 v34, v34
    v_exp_f32 v35, v35
    v_exp_f32 v36, v36
    v_smfmac_f32_32x32x32_bf16 v[64:79], v[144:147], v[24:31], v195
    v_exp_f32 v37, v37
    v_exp_f32 v38, v38
    v_exp_f32 v39, v39
    v_exp_f32 v40, v40
    v_exp_f32 v41, v41
    v_exp_f32 v42, v42
    v_smfmac_f32_32x32x32_bf16 v[80:95], v[140:143], v[32:39], v195
    ds_read_b64_tr_b16 v[140:141], v4 offset:12480
    ds_read_b64_tr_b16 v[142:143], v5 offset:12480
    s_add_u32 m0, m0, s29
    s_add_u32 s27, s27, 2048
    buffer_load_dwordx4 v8, s[12:15], s27 offen lds
    v_exp_f32 v43, v43
    v_exp_f32 v44, v44
    v_exp_f32 v45, v45
    v_exp_f32 v46, v46
    v_exp_f32 v47, v47
    v_mfma_f32_32x32x16_bf16 v[16:31], v[136:139], v[132:135], v[112:127]
    ds_read_b128 v[136:139], v3 offset:13312
    v_exp_f32 v48, v48
    v_exp_f32 v49, v49
    v_exp_f32 v50, v50
    v_exp_f32 v51, v51
    v_exp_f32 v52, v52
    v_smfmac_f32_32x32x32_bf16 v[80:95], v[144:147], v[40:47], v195
    ds_read_b64_tr_b16 v[144:145], v6 offset:12480
    ds_read_b64_tr_b16 v[146:147], v7 offset:12480
    v_exp_f32 v53, v53
    v_exp_f32 v54, v54
    v_exp_f32 v55, v55
    v_exp_f32 v56, v56
    v_exp_f32 v57, v57
    v_exp_f32 v58, v58
    s_waitcnt lgkmcnt(3)
    v_smfmac_f32_32x32x32_bf16 v[64:79], v[140:143], v[48:55], v195
    v_exp_f32 v59, v59
    v_exp_f32 v60, v60
    v_exp_f32 v61, v61
    v_exp_f32 v62, v62
    v_exp_f32 v63, v63
    s_waitcnt lgkmcnt(0)
    v_mfma_f32_32x32x16_bf16 v[32:47], v[136:139], v[128:131], v[96:111]
    v_exp_f32 v16, v16
    v_exp_f32 v17, v17
    v_exp_f32 v18, v18
    v_exp_f32 v19, v19
    v_exp_f32 v20, v20
    v_smfmac_f32_32x32x32_bf16 v[64:79], v[144:147], v[56:63], v195
    v_exp_f32 v21, v21
    v_exp_f32 v22, v22
    v_exp_f32 v23, v23
    v_exp_f32 v24, v24
    v_exp_f32 v25, v25
    v_exp_f32 v26, v26
    v_smfmac_f32_32x32x32_bf16 v[80:95], v[140:143], v[16:23], v195
    ds_read_b64_tr_b16 v[140:141], v4 offset:13520
    ds_read_b64_tr_b16 v[142:143], v5 offset:13520
    s_add_u32 m0, m0, s29
    s_add_u32 s27, s27, 2048
    buffer_load_dwordx4 v8, s[12:15], s27 offen lds
    v_exp_f32 v27, v27
    v_exp_f32 v28, v28
    v_exp_f32 v29, v29
    v_exp_f32 v30, v30
    v_exp_f32 v31, v31
    v_mfma_f32_32x32x16_bf16 v[48:63], v[136:139], v[132:135], v[112:127]
    ds_read_b128 v[136:139], v3 offset:14336
    v_exp_f32 v32, v32
    v_exp_f32 v33, v33
    v_exp_f32 v34, v34
    v_exp_f32 v35, v35
    v_exp_f32 v36, v36
    v_smfmac_f32_32x32x32_bf16 v[80:95], v[144:147], v[24:31], v195
    ds_read_b64_tr_b16 v[144:145], v6 offset:13520
    ds_read_b64_tr_b16 v[146:147], v7 offset:13520
    v_exp_f32 v37, v37
    v_exp_f32 v38, v38
    v_exp_f32 v39, v39
    v_exp_f32 v40, v40
    v_exp_f32 v41, v41
    v_exp_f32 v42, v42
    s_waitcnt lgkmcnt(3)
    v_smfmac_f32_32x32x32_bf16 v[64:79], v[140:143], v[32:39], v195
    v_exp_f32 v43, v43
    v_exp_f32 v44, v44
    v_exp_f32 v45, v45
    v_exp_f32 v46, v46
    v_exp_f32 v47, v47
    s_waitcnt lgkmcnt(0)
    v_mfma_f32_32x32x16_bf16 v[16:31], v[136:139], v[128:131], v[96:111]
    v_exp_f32 v48, v48
    v_exp_f32 v49, v49
    v_exp_f32 v50, v50
    v_exp_f32 v51, v51
    v_exp_f32 v52, v52
    v_smfmac_f32_32x32x32_bf16 v[64:79], v[144:147], v[40:47], v195
    v_exp_f32 v53, v53
    v_exp_f32 v54, v54
    v_exp_f32 v55, v55
    v_exp_f32 v56, v56
    v_exp_f32 v57, v57
    v_exp_f32 v58, v58
    v_smfmac_f32_32x32x32_bf16 v[80:95], v[140:143], v[48:55], v195
    ds_read_b64_tr_b16 v[140:141], v4 offset:14560
    ds_read_b64_tr_b16 v[142:143], v5 offset:14560
    s_add_u32 m0, m0, s29
    s_add_u32 s27, s27, 2048
    buffer_load_dwordx4 v8, s[12:15], s27 offen lds
    v_exp_f32 v59, v59
    v_exp_f32 v60, v60
    v_exp_f32 v61, v61
    v_exp_f32 v62, v62
    v_exp_f32 v63, v63
    v_mfma_f32_32x32x16_bf16 v[32:47], v[136:139], v[132:135], v[112:127]
    ds_read_b128 v[136:139], v3 offset:15360
    v_exp_f32 v16, v16
    v_exp_f32 v17, v17
    v_exp_f32 v18, v18
    v_exp_f32 v19, v19
    v_exp_f32 v20, v20
    v_smfmac_f32_32x32x32_bf16 v[80:95], v[144:147], v[56:63], v195
    ds_read_b64_tr_b16 v[144:145], v6 offset:14560
    ds_read_b64_tr_b16 v[146:147], v7 offset:14560
    v_exp_f32 v21, v21
    v_exp_f32 v22, v22
    v_exp_f32 v23, v23
    v_exp_f32 v24, v24
    v_exp_f32 v25, v25
    v_exp_f32 v26, v26
    s_waitcnt lgkmcnt(3)
    v_smfmac_f32_32x32x32_bf16 v[64:79], v[140:143], v[16:23], v195
    v_exp_f32 v27, v27
    v_exp_f32 v28, v28
    v_exp_f32 v29, v29
    v_exp_f32 v30, v30
    v_exp_f32 v31, v31
    s_waitcnt lgkmcnt(0)
    v_mfma_f32_32x32x16_bf16 v[48:63], v[136:139], v[128:131], v[96:111]
    v_exp_f32 v32, v32
    v_exp_f32 v33, v33
    v_exp_f32 v34, v34
    v_exp_f32 v35, v35
    v_exp_f32 v36, v36
    v_smfmac_f32_32x32x32_bf16 v[64:79], v[144:147], v[24:31], v195
    v_exp_f32 v37, v37
    v_exp_f32 v38, v38
    v_exp_f32 v39, v39
    v_exp_f32 v40, v40
    v_exp_f32 v41, v41
    v_exp_f32 v42, v42
    v_smfmac_f32_32x32x32_bf16 v[80:95], v[140:143], v[32:39], v195
    ds_read_b64_tr_b16 v[140:141], v4 offset:15600
    ds_read_b64_tr_b16 v[142:143], v5 offset:15600
    s_lshr_b32 s36, s24, 1
    s_add_u32 s36, s36, 60
    s_lshl_b32 s37, s36, 10
    s_mul_i32 s36, s36, 1040
    s_add_u32 s36, s36, 65552
    s_bitcmp0_b32 s24, 0
    s_cselect_b32 m0, s37, s36
    s_nop 0
    buffer_load_dwordx4 v8, s[12:15], s37 offen lds
    v_exp_f32 v43, v43
    v_exp_f32 v44, v44
    v_exp_f32 v45, v45
    v_exp_f32 v46, v46
    v_exp_f32 v47, v47
    v_mfma_f32_32x32x16_bf16 v[16:31], v[136:139], v[132:135], v[112:127]
    ds_read_b128 v[136:139], v3 offset:16384
    v_exp_f32 v48, v48
    v_exp_f32 v49, v49
    v_exp_f32 v50, v50
    v_exp_f32 v51, v51
    v_exp_f32 v52, v52
    v_smfmac_f32_32x32x32_bf16 v[80:95], v[144:147], v[40:47], v195
    ds_read_b64_tr_b16 v[144:145], v6 offset:15600
    ds_read_b64_tr_b16 v[146:147], v7 offset:15600
    v_exp_f32 v53, v53
    v_exp_f32 v54, v54
    v_exp_f32 v55, v55
    v_exp_f32 v56, v56
    v_exp_f32 v57, v57
    v_exp_f32 v58, v58
    s_waitcnt lgkmcnt(3)
    v_smfmac_f32_32x32x32_bf16 v[64:79], v[140:143], v[48:55], v195
    v_exp_f32 v59, v59
    v_exp_f32 v60, v60
    v_exp_f32 v61, v61
    v_exp_f32 v62, v62
    v_exp_f32 v63, v63
    s_waitcnt lgkmcnt(0)
    v_mfma_f32_32x32x16_bf16 v[32:47], v[136:139], v[128:131], v[96:111]
    v_exp_f32 v16, v16
    v_exp_f32 v17, v17
    v_exp_f32 v18, v18
    v_exp_f32 v19, v19
    v_exp_f32 v20, v20
    v_smfmac_f32_32x32x32_bf16 v[64:79], v[144:147], v[56:63], v195
    v_exp_f32 v21, v21
    v_exp_f32 v22, v22
    v_exp_f32 v23, v23
    v_exp_f32 v24, v24
    v_exp_f32 v25, v25
    v_exp_f32 v26, v26
    v_smfmac_f32_32x32x32_bf16 v[80:95], v[140:143], v[16:23], v195
    ds_read_b64_tr_b16 v[140:141], v4 offset:16640
    ds_read_b64_tr_b16 v[142:143], v5 offset:16640
    v_exp_f32 v27, v27
    v_exp_f32 v28, v28
    v_exp_f32 v29, v29
    v_exp_f32 v30, v30
    v_exp_f32 v31, v31
    v_mfma_f32_32x32x16_bf16 v[48:63], v[136:139], v[132:135], v[112:127]
    ds_read_b128 v[136:139], v3 offset:17408
    v_exp_f32 v32, v32
    v_exp_f32 v33, v33
    v_exp_f32 v34, v34
    v_exp_f32 v35, v35
    v_exp_f32 v36, v36
    v_smfmac_f32_32x32x32_bf16 v[80:95], v[144:147], v[24:31], v195
    ds_read_b64_tr_b16 v[144:145], v6 offset:16640
    ds_read_b64_tr_b16 v[146:147], v7 offset:16640
    v_exp_f32 v37, v37
    v_exp_f32 v38, v38
    v_exp_f32 v39, v39
    v_exp_f32 v40, v40
    v_exp_f32 v41, v41
    v_exp_f32 v42, v42
    s_waitcnt lgkmcnt(3)
    v_smfmac_f32_32x32x32_bf16 v[64:79], v[140:143], v[32:39], v195
    v_exp_f32 v43, v43
    v_exp_f32 v44, v44
    v_exp_f32 v45, v45
    v_exp_f32 v46, v46
    v_exp_f32 v47, v47
    s_waitcnt lgkmcnt(0)
    v_mfma_f32_32x32x16_bf16 v[16:31], v[136:139], v[128:131], v[96:111]
    v_exp_f32 v48, v48
    v_exp_f32 v49, v49
    v_exp_f32 v50, v50
    v_exp_f32 v51, v51
    v_exp_f32 v52, v52
    v_smfmac_f32_32x32x32_bf16 v[64:79], v[144:147], v[40:47], v195
    v_exp_f32 v53, v53
    v_exp_f32 v54, v54
    v_exp_f32 v55, v55
    v_exp_f32 v56, v56
    v_exp_f32 v57, v57
    v_exp_f32 v58, v58
    v_smfmac_f32_32x32x32_bf16 v[80:95], v[140:143], v[48:55], v195
    ds_read_b64_tr_b16 v[140:141], v4 offset:17680
    ds_read_b64_tr_b16 v[142:143], v5 offset:17680
    v_exp_f32 v59, v59
    v_exp_f32 v60, v60
    v_exp_f32 v61, v61
    v_exp_f32 v62, v62
    v_exp_f32 v63, v63
    v_mfma_f32_32x32x16_bf16 v[32:47], v[136:139], v[132:135], v[112:127]
    ds_read_b128 v[136:139], v3 offset:18432
    v_exp_f32 v16, v16
    v_exp_f32 v17, v17
    v_exp_f32 v18, v18
    v_exp_f32 v19, v19
    v_exp_f32 v20, v20
    v_smfmac_f32_32x32x32_bf16 v[80:95], v[144:147], v[56:63], v195
    ds_read_b64_tr_b16 v[144:145], v6 offset:17680
    ds_read_b64_tr_b16 v[146:147], v7 offset:17680
    v_exp_f32 v21, v21
    v_exp_f32 v22, v22
    v_exp_f32 v23, v23
    v_exp_f32 v24, v24
    v_exp_f32 v25, v25
    v_exp_f32 v26, v26
    s_waitcnt lgkmcnt(3)
    v_smfmac_f32_32x32x32_bf16 v[64:79], v[140:143], v[16:23], v195
    v_exp_f32 v27, v27
    v_exp_f32 v28, v28
    v_exp_f32 v29, v29
    v_exp_f32 v30, v30
    v_exp_f32 v31, v31
    s_waitcnt lgkmcnt(0)
    v_mfma_f32_32x32x16_bf16 v[48:63], v[136:139], v[128:131], v[96:111]
    v_exp_f32 v32, v32
    v_exp_f32 v33, v33
    v_exp_f32 v34, v34
    v_exp_f32 v35, v35
    v_exp_f32 v36, v36
    v_smfmac_f32_32x32x32_bf16 v[64:79], v[144:147], v[24:31], v195
    v_exp_f32 v37, v37
    v_exp_f32 v38, v38
    v_exp_f32 v39, v39
    v_exp_f32 v40, v40
    v_exp_f32 v41, v41
    v_exp_f32 v42, v42
    v_smfmac_f32_32x32x32_bf16 v[80:95], v[140:143], v[32:39], v195
    ds_read_b64_tr_b16 v[140:141], v4 offset:18720
    ds_read_b64_tr_b16 v[142:143], v5 offset:18720
    s_waitcnt vmcnt(1)
    s_mov_b64 exec, 1
    ds_add_u32 v10, v13 offset:20
    s_mov_b64 exec, -1
    v_exp_f32 v43, v43
    v_exp_f32 v44, v44
    v_exp_f32 v45, v45
    v_exp_f32 v46, v46
    v_exp_f32 v47, v47
    v_mfma_f32_32x32x16_bf16 v[16:31], v[136:139], v[132:135], v[112:127]
    ds_read_b128 v[136:139], v3 offset:19456
    v_exp_f32 v48, v48
    v_exp_f32 v49, v49
    v_exp_f32 v50, v50
    v_exp_f32 v51, v51
    v_exp_f32 v52, v52
    v_smfmac_f32_32x32x32_bf16 v[80:95], v[144:147], v[40:47], v195
    ds_read_b64_tr_b16 v[144:145], v6 offset:18720
    ds_read_b64_tr_b16 v[146:147], v7 offset:18720
    v_exp_f32 v53, v53
    v_exp_f32 v54, v54
    v_exp_f32 v55, v55
    v_exp_f32 v56, v56
    v_exp_f32 v57, v57
    v_exp_f32 v58, v58
    s_waitcnt lgkmcnt(4)
    v_smfmac_f32_32x32x32_bf16 v[64:79], v[140:143], v[48:55], v195
    v_exp_f32 v59, v59
    v_exp_f32 v60, v60
    v_exp_f32 v61, v61
    v_exp_f32 v62, v62
    v_exp_f32 v63, v63
    s_waitcnt lgkmcnt(0)
    v_mfma_f32_32x32x16_bf16 v[32:47], v[136:139], v[128:131], v[96:111]
    v_exp_f32 v16, v16
    v_exp_f32 v17, v17
    v_exp_f32 v18, v18
    v_exp_f32 v19, v19
    v_exp_f32 v20, v20
    v_smfmac_f32_32x32x32_bf16 v[64:79], v[144:147], v[56:63], v195
    ds_read_b32 v12, v10 offset:20
    v_exp_f32 v21, v21
    v_exp_f32 v22, v22
    v_exp_f32 v23, v23
    v_exp_f32 v24, v24
    v_exp_f32 v25, v25
    v_exp_f32 v26, v26
    v_smfmac_f32_32x32x32_bf16 v[80:95], v[140:143], v[16:23], v195
    ds_read_b64_tr_b16 v[140:141], v4 offset:19760
    ds_read_b64_tr_b16 v[142:143], v5 offset:19760
    s_waitcnt vmcnt(0)
    s_mov_b64 exec, 1
    ds_add_u32 v200, v13 offset:0
    s_mov_b64 exec, -1
    v_exp_f32 v27, v27
    v_exp_f32 v28, v28
    v_exp_f32 v29, v29
    v_exp_f32 v30, v30
    v_exp_f32 v31, v31
    v_mfma_f32_32x32x16_bf16 v[48:63], v[136:139], v[132:135], v[112:127]
    s_waitcnt lgkmcnt(3)
    v_cmp_ne_u32 vcc, 4, v12
    s_cbranch_vccnz L_wg5
L_rg5:
    ds_read_b128 v[136:139], v3 offset:20480
    v_exp_f32 v32, v32
    v_exp_f32 v33, v33
    v_exp_f32 v34, v34
    v_exp_f32 v35, v35
    v_exp_f32 v36, v36
    v_smfmac_f32_32x32x32_bf16 v[80:95], v[144:147], v[24:31], v195
    ds_read_b64_tr_b16 v[144:145], v6 offset:19760
    ds_read_b64_tr_b16 v[146:147], v7 offset:19760
    v_exp_f32 v37, v37
    v_exp_f32 v38, v38
    v_exp_f32 v39, v39
    v_exp_f32 v40, v40
    v_exp_f32 v41, v41
    v_exp_f32 v42, v42
    s_waitcnt lgkmcnt(4)
    v_smfmac_f32_32x32x32_bf16 v[64:79], v[140:143], v[32:39], v195
    v_exp_f32 v43, v43
    v_exp_f32 v44, v44
    v_exp_f32 v45, v45
    v_exp_f32 v46, v46
    v_exp_f32 v47, v47
    s_waitcnt lgkmcnt(0)
    v_mfma_f32_32x32x16_bf16 v[16:31], v[136:139], v[128:131], v[96:111]
    v_exp_f32 v48, v48
    v_exp_f32 v49, v49
    v_exp_f32 v50, v50
    v_exp_f32 v51, v51
    v_exp_f32 v52, v52
    v_smfmac_f32_32x32x32_bf16 v[64:79], v[144:147], v[40:47], v195
    v_exp_f32 v53, v53
    v_exp_f32 v54, v54
    v_exp_f32 v55, v55
    v_exp_f32 v56, v56
    v_exp_f32 v57, v57
    v_exp_f32 v58, v58
    v_smfmac_f32_32x32x32_bf16 v[80:95], v[140:143], v[48:55], v195
    ds_read_b64_tr_b16 v[140:141], v4 offset:20800
    ds_read_b64_tr_b16 v[142:143], v5 offset:20800
    v_exp_f32 v59, v59
    v_exp_f32 v60, v60
    v_exp_f32 v61, v61
    v_exp_f32 v62, v62
    v_exp_f32 v63, v63
    v_mfma_f32_32x32x16_bf16 v[32:47], v[136:139], v[132:135], v[112:127]
    ds_read_b128 v[136:139], v3 offset:21504
    v_exp_f32 v16, v16
    v_exp_f32 v17, v17
    v_exp_f32 v18, v18
    v_exp_f32 v19, v19
    v_exp_f32 v20, v20
    v_smfmac_f32_32x32x32_bf16 v[80:95], v[144:147], v[56:63], v195
    ds_read_b64_tr_b16 v[144:145], v6 offset:20800
    ds_read_b64_tr_b16 v[146:147], v7 offset:20800
    v_exp_f32 v21, v21
    v_exp_f32 v22, v22
    v_exp_f32 v23, v23
    v_exp_f32 v24, v24
    v_exp_f32 v25, v25
    v_exp_f32 v26, v26
    s_waitcnt lgkmcnt(3)
    v_smfmac_f32_32x32x32_bf16 v[64:79], v[140:143], v[16:23], v195
    v_exp_f32 v27, v27
    v_exp_f32 v28, v28
    v_exp_f32 v29, v29
    v_exp_f32 v30, v30
    v_exp_f32 v31, v31
    s_waitcnt lgkmcnt(0)
    v_mfma_f32_32x32x16_bf16 v[48:63], v[136:139], v[128:131], v[96:111]
    v_exp_f32 v32, v32
    v_exp_f32 v33, v33
    v_exp_f32 v34, v34
    v_exp_f32 v35, v35
    v_exp_f32 v36, v36
    v_smfmac_f32_32x32x32_bf16 v[64:79], v[144:147], v[24:31], v195
    v_exp_f32 v37, v37
    v_exp_f32 v38, v38
    v_exp_f32 v39, v39
    v_exp_f32 v40, v40
    v_exp_f32 v41, v41
    v_exp_f32 v42, v42
    v_smfmac_f32_32x32x32_bf16 v[80:95], v[140:143], v[32:39], v195
    ds_read_b64_tr_b16 v[140:141], v4 offset:21840
    ds_read_b64_tr_b16 v[142:143], v5 offset:21840
    v_exp_f32 v43, v43
    v_exp_f32 v44, v44
    v_exp_f32 v45, v45
    v_exp_f32 v46, v46
    v_exp_f32 v47, v47
    v_mfma_f32_32x32x16_bf16 v[16:31], v[136:139], v[132:135], v[112:127]
    ds_read_b128 v[136:139], v3 offset:22528
    v_exp_f32 v48, v48
    v_exp_f32 v49, v49
    v_exp_f32 v50, v50
    v_exp_f32 v51, v51
    v_exp_f32 v52, v52
    v_smfmac_f32_32x32x32_bf16 v[80:95], v[144:147], v[40:47], v195
    ds_read_b64_tr_b16 v[144:145], v6 offset:21840
    ds_read_b64_tr_b16 v[146:147], v7 offset:21840
    v_exp_f32 v53, v53
    v_exp_f32 v54, v54
    v_exp_f32 v55, v55
    v_exp_f32 v56, v56
    v_exp_f32 v57, v57
    v_exp_f32 v58, v58
    s_waitcnt lgkmcnt(3)
    v_smfmac_f32_32x32x32_bf16 v[64:79], v[140:143], v[48:55], v195
    v_exp_f32 v59, v59
    v_exp_f32 v60, v60
    v_exp_f32 v61, v61
    v_exp_f32 v62, v62
    v_exp_f32 v63, v63
    s_waitcnt lgkmcnt(0)
    v_mfma_f32_32x32x16_bf16 v[32:47], v[136:139], v[128:131], v[96:111]
    v_exp_f32 v16, v16
    v_exp_f32 v17, v17
    v_exp_f32 v18, v18
    v_exp_f32 v19, v19
    v_exp_f32 v20, v20
    v_smfmac_f32_32x32x32_bf16 v[64:79], v[144:147], v[56:63], v195
    v_exp_f32 v21, v21
    v_exp_f32 v22, v22
    v_exp_f32 v23, v23
    v_exp_f32 v24, v24
    v_exp_f32 v25, v25
    v_exp_f32 v26, v26
    v_smfmac_f32_32x32x32_bf16 v[80:95], v[140:143], v[16:23], v195
    ds_read_b64_tr_b16 v[140:141], v4 offset:22880
    ds_read_b64_tr_b16 v[142:143], v5 offset:22880
    v_exp_f32 v27, v27
    v_exp_f32 v28, v28
    v_exp_f32 v29, v29
    v_exp_f32 v30, v30
    v_exp_f32 v31, v31
    v_mfma_f32_32x32x16_bf16 v[48:63], v[136:139], v[132:135], v[112:127]
    ds_read_b128 v[136:139], v3 offset:23552
    v_exp_f32 v32, v32
    v_exp_f32 v33, v33
    v_exp_f32 v34, v34
    v_exp_f32 v35, v35
    v_exp_f32 v36, v36
    v_smfmac_f32_32x32x32_bf16 v[80:95], v[144:147], v[24:31], v195
    ds_read_b64_tr_b16 v[144:145], v6 offset:22880
    ds_read_b64_tr_b16 v[146:147], v7 offset:22880
    v_exp_f32 v37, v37
    v_exp_f32 v38, v38
    v_exp_f32 v39, v39
    v_exp_f32 v40, v40
    v_exp_f32 v41, v41
    v_exp_f32 v42, v42
    s_waitcnt lgkmcnt(3)
    v_smfmac_f32_32x32x32_bf16 v[64:79], v[140:143], v[32:39], v195
    v_exp_f32 v43, v43
    v_exp_f32 v44, v44
    v_exp_f32 v45, v45
    v_exp_f32 v46, v46
    v_exp_f32 v47, v47
    s_waitcnt lgkmcnt(0)
    v_mfma_f32_32x32x16_bf16 v[16:31], v[136:139], v[128:131], v[96:111]
    v_exp_f32 v48, v48
    v_exp_f32 v49, v49
    v_exp_f32 v50, v50
    v_exp_f32 v51, v51
    v_exp_f32 v52, v52
    v_smfmac_f32_32x32x32_bf16 v[64:79], v[144:147], v[40:47], v195
    v_exp_f32 v53, v53
    v_exp_f32 v54, v54
    v_exp_f32 v55, v55
    v_exp_f32 v56, v56
    v_exp_f32 v57, v57
    v_exp_f32 v58, v58
    v_smfmac_f32_32x32x32_bf16 v[80:95], v[140:143], v[48:55], v195
    ds_read_b64_tr_b16 v[140:141], v4 offset:23920
    ds_read_b64_tr_b16 v[142:143], v5 offset:23920
    v_exp_f32 v59, v59
    v_exp_f32 v60, v60
    v_exp_f32 v61, v61
    v_exp_f32 v62, v62
    v_exp_f32 v63, v63
    v_mfma_f32_32x32x16_bf16 v[32:47], v[136:139], v[132:135], v[112:127]
    ds_read_b128 v[136:139], v3 offset:24576
    v_exp_f32 v16, v16
    v_exp_f32 v17, v17
    v_exp_f32 v18, v18
    v_exp_f32 v19, v19
    v_exp_f32 v20, v20
    v_smfmac_f32_32x32x32_bf16 v[80:95], v[144:147], v[56:63], v195
    ds_read_b64_tr_b16 v[144:145], v6 offset:23920
    ds_read_b64_tr_b16 v[146:147], v7 offset:23920
    v_exp_f32 v21, v21
    v_exp_f32 v22, v22
    v_exp_f32 v23, v23
    v_exp_f32 v24, v24
    v_exp_f32 v25, v25
    v_exp_f32 v26, v26
    s_waitcnt lgkmcnt(3)
    v_smfmac_f32_32x32x32_bf16 v[64:79], v[140:143], v[16:23], v195
    v_exp_f32 v27, v27
    v_exp_f32 v28, v28
    v_exp_f32 v29, v29
    v_exp_f32 v30, v30
    v_exp_f32 v31, v31
    s_waitcnt lgkmcnt(0)
    v_mfma_f32_32x32x16_bf16 v[48:63], v[136:139], v[128:131], v[96:111]
    v_exp_f32 v32, v32
    v_exp_f32 v33, v33
    v_exp_f32 v34, v34
    v_exp_f32 v35, v35
    v_exp_f32 v36, v36
    v_smfmac_f32_32x32x32_bf16 v[64:79], v[144:147], v[24:31], v195
    v_exp_f32 v37, v37
    v_exp_f32 v38, v38
    v_exp_f32 v39, v39
    v_exp_f32 v40, v40
    v_exp_f32 v41, v41
    v_exp_f32 v42, v42
    v_smfmac_f32_32x32x32_bf16 v[80:95], v[140:143], v[32:39], v195
    ds_read_b64_tr_b16 v[140:141], v4 offset:24960
    ds_read_b64_tr_b16 v[142:143], v5 offset:24960
    v_exp_f32 v43, v43
    v_exp_f32 v44, v44
    v_exp_f32 v45, v45
    v_exp_f32 v46, v46
    v_exp_f32 v47, v47
    v_mfma_f32_32x32x16_bf16 v[16:31], v[136:139], v[132:135], v[112:127]
    ds_read_b128 v[136:139], v3 offset:25600
    v_exp_f32 v48, v48
    v_exp_f32 v49, v49
    v_exp_f32 v50, v50
    v_exp_f32 v51, v51
    v_exp_f32 v52, v52
    v_smfmac_f32_32x32x32_bf16 v[80:95], v[144:147], v[40:47], v195
    ds_read_b64_tr_b16 v[144:145], v6 offset:24960
    ds_read_b64_tr_b16 v[146:147], v7 offset:24960
    v_exp_f32 v53, v53
    v_exp_f32 v54, v54
    v_exp_f32 v55, v55
    v_exp_f32 v56, v56
    v_exp_f32 v57, v57
    v_exp_f32 v58, v58
    s_waitcnt lgkmcnt(3)
    v_smfmac_f32_32x32x32_bf16 v[64:79], v[140:143], v[48:55], v195
    v_exp_f32 v59, v59
    v_exp_f32 v60, v60
    v_exp_f32 v61, v61
    v_exp_f32 v62, v62
    v_exp_f32 v63, v63
    s_waitcnt lgkmcnt(0)
    v_mfma_f32_32x32x16_bf16 v[32:47], v[136:139], v[128:131], v[96:111]
    v_exp_f32 v16, v16
    v_exp_f32 v17, v17
    v_exp_f32 v18, v18
    v_exp_f32 v19, v19
    v_exp_f32 v20, v20
    v_smfmac_f32_32x32x32_bf16 v[64:79], v[144:147], v[56:63], v195
    v_exp_f32 v21, v21
    v_exp_f32 v22, v22
    v_exp_f32 v23, v23
    v_exp_f32 v24, v24
    v_exp_f32 v25, v25
    v_exp_f32 v26, v26
    v_smfmac_f32_32x32x32_bf16 v[80:95], v[140:143], v[16:23], v195
    ds_read_b64_tr_b16 v[140:141], v4 offset:26000
    ds_read_b64_tr_b16 v[142:143], v5 offset:26000
    v_exp_f32 v27, v27
    v_exp_f32 v28, v28
    v_exp_f32 v29, v29
    v_exp_f32 v30, v30
    v_exp_f32 v31, v31
    s_setprio 2
    v_mfma_f32_32x32x16_bf16 v[48:63], v[136:139], v[132:135], v[112:127]
    ds_read_b128 v[136:139], v3 offset:26624
    v_exp_f32 v32, v32
    v_exp_f32 v33, v33
    v_exp_f32 v34, v34
    v_exp_f32 v35, v35
    v_exp_f32 v36, v36
    v_smfmac_f32_32x32x32_bf16 v[80:95], v[144:147], v[24:31], v195
    ds_read_b64_tr_b16 v[144:145], v6 offset:26000
    ds_read_b64_tr_b16 v[146:147], v7 offset:26000
    v_exp_f32 v37, v37
    v_exp_f32 v38, v38
    v_exp_f32 v39, v39
    v_exp_f32 v40, v40
    v_exp_f32 v41, v41
    v_exp_f32 v42, v42
    s_waitcnt lgkmcnt(3)
    v_smfmac_f32_32x32x32_bf16 v[64:79], v[140:143], v[32:39], v195
    v_exp_f32 v43, v43
    v_exp_f32 v44, v44
    v_exp_f32 v45, v45
    v_exp_f32 v46, v46
    v_exp_f32 v47, v47
    s_waitcnt lgkmcnt(0)
    v_mfma_f32_32x32x16_bf16 v[16:31], v[136:139], v[128:131], v[96:111]
    v_exp_f32 v48, v48
    v_exp_f32 v49, v49
    v_exp_f32 v50, v50
    v_exp_f32 v51, v51
    v_exp_f32 v52, v52
    v_smfmac_f32_32x32x32_bf16 v[64:79], v[144:147], v[40:47], v195
    v_exp_f32 v53, v53
    v_exp_f32 v54, v54
    v_exp_f32 v55, v55
    v_exp_f32 v56, v56
    v_exp_f32 v57, v57
    v_exp_f32 v58, v58
    v_smfmac_f32_32x32x32_bf16 v[80:95], v[140:143], v[48:55], v195
    ds_read_b64_tr_b16 v[140:141], v4 offset:27040
    ds_read_b64_tr_b16 v[142:143], v5 offset:27040
    v_exp_f32 v59, v59
    v_exp_f32 v60, v60
    v_exp_f32 v61, v61
    v_exp_f32 v62, v62
    v_exp_f32 v63, v63
    v_mfma_f32_32x32x16_bf16 v[32:47], v[136:139], v[132:135], v[112:127]
    ds_read_b128 v[136:139], v3 offset:27648
    v_exp_f32 v16, v16
    v_exp_f32 v17, v17
    v_exp_f32 v18, v18
    v_exp_f32 v19, v19
    v_exp_f32 v20, v20
    v_smfmac_f32_32x32x32_bf16 v[80:95], v[144:147], v[56:63], v195
    ds_read_b64_tr_b16 v[144:145], v6 offset:27040
    ds_read_b64_tr_b16 v[146:147], v7 offset:27040
    v_exp_f32 v21, v21
    v_exp_f32 v22, v22
    v_exp_f32 v23, v23
    v_exp_f32 v24, v24
    v_exp_f32 v25, v25
    v_exp_f32 v26, v26
    s_waitcnt lgkmcnt(3)
    v_smfmac_f32_32x32x32_bf16 v[64:79], v[140:143], v[16:23], v195
    v_exp_f32 v27, v27
    v_exp_f32 v28, v28
    v_exp_f32 v29, v29
    v_exp_f32 v30, v30
    v_exp_f32 v31, v31
    s_waitcnt lgkmcnt(0)
    v_mfma_f32_32x32x16_bf16 v[48:63], v[136:139], v[128:131], v[96:111]
    v_exp_f32 v32, v32
    v_exp_f32 v33, v33
    v_exp_f32 v34, v34
    v_exp_f32 v35, v35
    v_exp_f32 v36, v36
    v_smfmac_f32_32x32x32_bf16 v[64:79], v[144:147], v[24:31], v195
    v_exp_f32 v37, v37
    v_exp_f32 v38, v38
    v_exp_f32 v39, v39
    v_exp_f32 v40, v40
    v_exp_f32 v41, v41
    v_exp_f32 v42, v42
    v_smfmac_f32_32x32x32_bf16 v[80:95], v[140:143], v[32:39], v195
    ds_read_b64_tr_b16 v[140:141], v4 offset:28080
    ds_read_b64_tr_b16 v[142:143], v5 offset:28080
    v_exp_f32 v43, v43
    v_exp_f32 v44, v44
    v_exp_f32 v45, v45
    v_exp_f32 v46, v46
    v_exp_f32 v47, v47
    v_mfma_f32_32x32x16_bf16 v[16:31], v[136:139], v[132:135], v[112:127]
    ds_read_b128 v[136:139], v3 offset:28672
    v_exp_f32 v48, v48
    v_exp_f32 v49, v49
    v_exp_f32 v50, v50
    v_exp_f32 v51, v51
    v_exp_f32 v52, v52
    v_smfmac_f32_32x32x32_bf16 v[80:95], v[144:147], v[40:47], v195
    ds_read_b64_tr_b16 v[144:145], v6 offset:28080
    ds_read_b64_tr_b16 v[146:147], v7 offset:28080
    v_exp_f32 v53, v53
    v_exp_f32 v54, v54
    v_exp_f32 v55, v55
    v_exp_f32 v56, v56
    v_exp_f32 v57, v57
    v_exp_f32 v58, v58
    s_waitcnt lgkmcnt(3)
    v_smfmac_f32_32x32x32_bf16 v[64:79], v[140:143], v[48:55], v195
    v_exp_f32 v59, v59
    v_exp_f32 v60, v60
    v_exp_f32 v61, v61
    v_exp_f32 v62, v62
    v_exp_f32 v63, v63
    s_waitcnt lgkmcnt(0)
    v_mfma_f32_32x32x16_bf16 v[32:47], v[136:139], v[128:131], v[96:111]
    v_exp_f32 v16, v16
    v_exp_f32 v17, v17
    v_exp_f32 v18, v18
    v_exp_f32 v19, v19
    v_exp_f32 v20, v20
    v_smfmac_f32_32x32x32_bf16 v[64:79], v[144:147], v[56:63], v195
    v_exp_f32 v21, v21
    v_exp_f32 v22, v22
    v_exp_f32 v23, v23
    v_exp_f32 v24, v24
    v_exp_f32 v25, v25
    v_exp_f32 v26, v26
    v_smfmac_f32_32x32x32_bf16 v[80:95], v[140:143], v[16:23], v195
    ds_read_b64_tr_b16 v[140:141], v4 offset:29120
    ds_read_b64_tr_b16 v[142:143], v5 offset:29120
    v_exp_f32 v27, v27
    v_exp_f32 v28, v28
    v_exp_f32 v29, v29
    v_exp_f32 v30, v30
    v_exp_f32 v31, v31
    v_mfma_f32_32x32x16_bf16 v[48:63], v[136:139], v[132:135], v[112:127]
    ds_read_b128 v[136:139], v3 offset:29696
    v_exp_f32 v32, v32
    v_exp_f32 v33, v33
    v_exp_f32 v34, v34
    v_exp_f32 v35, v35
    v_exp_f32 v36, v36
    v_smfmac_f32_32x32x32_bf16 v[80:95], v[144:147], v[24:31], v195
    ds_read_b64_tr_b16 v[144:145], v6 offset:29120
    ds_read_b64_tr_b16 v[146:147], v7 offset:29120
    v_exp_f32 v37, v37
    v_exp_f32 v38, v38
    v_exp_f32 v39, v39
    v_exp_f32 v40, v40
    v_exp_f32 v41, v41
    v_exp_f32 v42, v42
    s_waitcnt lgkmcnt(3)
    v_smfmac_f32_32x32x32_bf16 v[64:79], v[140:143], v[32:39], v195
    v_exp_f32 v43, v43
    v_exp_f32 v44, v44
    v_exp_f32 v45, v45
    v_exp_f32 v46, v46
    v_exp_f32 v47, v47
    s_waitcnt lgkmcnt(0)
    v_mfma_f32_32x32x16_bf16 v[16:31], v[136:139], v[128:131], v[96:111]
    v_exp_f32 v48, v48
    v_exp_f32 v49, v49
    v_exp_f32 v50, v50
    v_exp_f32 v51, v51
    v_exp_f32 v52, v52
    v_smfmac_f32_32x32x32_bf16 v[64:79], v[144:147], v[40:47], v195
    v_exp_f32 v53, v53
    v_exp_f32 v54, v54
    v_exp_f32 v55, v55
    v_exp_f32 v56, v56
    v_exp_f32 v57, v57
    v_exp_f32 v58, v58
    v_smfmac_f32_32x32x32_bf16 v[80:95], v[140:143], v[48:55], v195
    ds_read_b64_tr_b16 v[140:141], v4 offset:30160
    ds_read_b64_tr_b16 v[142:143], v5 offset:30160
    v_exp_f32 v59, v59
    v_exp_f32 v60, v60
    v_exp_f32 v61, v61
    v_exp_f32 v62, v62
    v_exp_f32 v63, v63
    v_mfma_f32_32x32x16_bf16 v[32:47], v[136:139], v[132:135], v[112:127]
    ds_read_b128 v[136:139], v3 offset:30720
    v_exp_f32 v16, v16
    v_exp_f32 v17, v17
    v_exp_f32 v18, v18
    v_exp_f32 v19, v19
    v_exp_f32 v20, v20
    v_smfmac_f32_32x32x32_bf16 v[80:95], v[144:147], v[56:63], v195
    ds_read_b64_tr_b16 v[144:145], v6 offset:30160
    ds_read_b64_tr_b16 v[146:147], v7 offset:30160
    v_exp_f32 v21, v21
    v_exp_f32 v22, v22
    v_exp_f32 v23, v23
    v_exp_f32 v24, v24
    v_exp_f32 v25, v25
    v_exp_f32 v26, v26
    s_waitcnt lgkmcnt(3)
    v_smfmac_f32_32x32x32_bf16 v[64:79], v[140:143], v[16:23], v195
    v_exp_f32 v27, v27
    v_exp_f32 v28, v28
    v_exp_f32 v29, v29
    v_exp_f32 v30, v30
    v_exp_f32 v31, v31
    s_waitcnt lgkmcnt(0)
    v_mfma_f32_32x32x16_bf16 v[48:63], v[136:139], v[128:131], v[96:111]
    v_exp_f32 v32, v32
    v_exp_f32 v33, v33
    v_exp_f32 v34, v34
    v_exp_f32 v35, v35
    v_exp_f32 v36, v36
    v_smfmac_f32_32x32x32_bf16 v[64:79], v[144:147], v[24:31], v195
    v_exp_f32 v37, v37
    v_exp_f32 v38, v38
    v_exp_f32 v39, v39
    v_exp_f32 v40, v40
    v_exp_f32 v41, v41
    v_exp_f32 v42, v42
    v_smfmac_f32_32x32x32_bf16 v[80:95], v[140:143], v[32:39], v195
    ds_read_b64_tr_b16 v[140:141], v4 offset:31200
    ds_read_b64_tr_b16 v[142:143], v5 offset:31200
    v_exp_f32 v43, v43
    v_exp_f32 v44, v44
    v_exp_f32 v45, v45
    v_exp_f32 v46, v46
    v_exp_f32 v47, v47
    v_mfma_f32_32x32x16_bf16 v[16:31], v[136:139], v[132:135], v[112:127]
    ds_read_b128 v[136:139], v3 offset:31744
    v_exp_f32 v48, v48
    v_exp_f32 v49, v49
    v_exp_f32 v50, v50
    v_exp_f32 v51, v51
    v_exp_f32 v52, v52
    v_smfmac_f32_32x32x32_bf16 v[80:95], v[144:147], v[40:47], v195
    ds_read_b64_tr_b16 v[144:145], v6 offset:31200
    ds_read_b64_tr_b16 v[146:147], v7 offset:31200
    v_exp_f32 v53, v53
    v_exp_f32 v54, v54
    v_exp_f32 v55, v55
    v_exp_f32 v56, v56
    v_exp_f32 v57, v57
    v_exp_f32 v58, v58
    s_waitcnt lgkmcnt(3)
    v_smfmac_f32_32x32x32_bf16 v[64:79], v[140:143], v[48:55], v195
    v_exp_f32 v59, v59
    v_exp_f32 v60, v60
    v_exp_f32 v61, v61
    v_exp_f32 v62, v62
    v_exp_f32 v63, v63
    s_setprio 1
    s_waitcnt lgkmcnt(0)
    v_mfma_f32_32x32x16_bf16 v[32:47], v[136:139], v[128:131], v[96:111]
    v_exp_f32 v16, v16
    v_exp_f32 v17, v17
    v_exp_f32 v18, v18
    v_exp_f32 v19, v19
    v_exp_f32 v20, v20
    v_smfmac_f32_32x32x32_bf16 v[64:79], v[144:147], v[56:63], v195
    ds_read_b32 v14, v200
    v_exp_f32 v21, v21
    v_exp_f32 v22, v22
    v_exp_f32 v23, v23
    v_exp_f32 v24, v24
    v_exp_f32 v25, v25
    v_exp_f32 v26, v26
    v_smfmac_f32_32x32x32_bf16 v[80:95], v[140:143], v[16:23], v195
    ds_read_b64_tr_b16 v[140:141], v4 offset:32240
    ds_read_b64_tr_b16 v[142:143], v5 offset:32240
    v_exp_f32 v27, v27
    v_exp_f32 v28, v28
    v_exp_f32 v29, v29
    v_exp_f32 v30, v30
    v_exp_f32 v31, v31
    v_mfma_f32_32x32x16_bf16 v[48:63], v[136:139], v[132:135], v[112:127]
    s_waitcnt lgkmcnt(2)
    v_cmp_ne_u32 vcc, 8, v14
    s_cbranch_vccnz L_wfin
L_rfin:
    ds_read_b128 v[136:139], v190 offset:61440
    v_exp_f32 v32, v32
    v_exp_f32 v33, v33
    v_exp_f32 v34, v34
    v_exp_f32 v35, v35
    v_exp_f32 v36, v36
    v_smfmac_f32_32x32x32_bf16 v[80:95], v[144:147], v[24:31], v195
    ds_read_b64_tr_b16 v[144:145], v6 offset:32240
    ds_read_b64_tr_b16 v[146:147], v7 offset:32240
    v_exp_f32 v37, v37
    v_exp_f32 v38, v38
    v_exp_f32 v39, v39
    v_exp_f32 v40, v40
    v_exp_f32 v41, v41
    v_exp_f32 v42, v42
    s_waitcnt lgkmcnt(3)
    v_smfmac_f32_32x32x32_bf16 v[64:79], v[140:143], v[32:39], v195
    v_exp_f32 v43, v43
    v_exp_f32 v44, v44
    v_exp_f32 v45, v45
    v_exp_f32 v46, v46
    v_exp_f32 v47, v47
    s_waitcnt lgkmcnt(0)
    v_mfma_f32_32x32x16_bf16 v[16:31], v[136:139], v[128:131], v[96:111]
    ds_read_b128 v[136:139], v190 offset:62464
    v_exp_f32 v48, v48
    v_exp_f32 v49, v49
    v_exp_f32 v50, v50
    v_exp_f32 v51, v51
    v_exp_f32 v52, v52
    v_smfmac_f32_32x32x32_bf16 v[64:79], v[144:147], v[40:47], v195
    v_exp_f32 v53, v53
    v_exp_f32 v54, v54
    v_exp_f32 v55, v55
    v_exp_f32 v56, v56
    v_exp_f32 v57, v57
    v_exp_f32 v58, v58
    v_smfmac_f32_32x32x32_bf16 v[80:95], v[140:143], v[48:55], v195
    ds_read_b64_tr_b16 v[140:141], v191 offset:62400
    ds_read_b64_tr_b16 v[142:143], v192 offset:62400
    v_exp_f32 v59, v59
    v_exp_f32 v60, v60
    v_exp_f32 v61, v61
    v_exp_f32 v62, v62
    v_exp_f32 v63, v63
    s_waitcnt lgkmcnt(2)
    v_mfma_f32_32x32x16_bf16 v[32:47], v[136:139], v[128:131], v[96:111]
    ds_read_b128 v[136:139], v190 offset:63488
    v_exp_f32 v16, v16
    v_exp_f32 v17, v17
    v_exp_f32 v18, v18
    v_exp_f32 v19, v19
    v_exp_f32 v20, v20
    v_smfmac_f32_32x32x32_bf16 v[80:95], v[144:147], v[56:63], v195
    ds_read_b64_tr_b16 v[144:145], v193 offset:62400
    ds_read_b64_tr_b16 v[146:147], v194 offset:62400
    v_exp_f32 v21, v21
    v_exp_f32 v22, v22
    v_exp_f32 v23, v23
    v_exp_f32 v24, v24
    v_exp_f32 v25, v25
    v_exp_f32 v26, v26
    s_waitcnt lgkmcnt(3)
    v_smfmac_f32_32x32x32_bf16 v[64:79], v[140:143], v[16:23], v195
    ds_read_b64_tr_b16 v[140:141], v191 offset:63440
    ds_read_b64_tr_b16 v[142:143], v192 offset:63440
    v_exp_f32 v27, v27
    v_exp_f32 v28, v28
    v_exp_f32 v29, v29
    v_exp_f32 v30, v30
    v_exp_f32 v31, v31
    s_waitcnt lgkmcnt(2)
    v_mfma_f32_32x32x16_bf16 v[48:63], v[136:139], v[128:131], v[96:111]
    ds_read_b128 v[136:139], v190 offset:64512
    ds_write_b128 v9, v[80:83] offset:0
    ds_write_b128 v9, v[84:87] offset:1024
    ds_write_b32 v1, v88 offset:2048
    s_mov_b64 exec, 1
    ds_add_u32 v198, v13 offset:8
    s_mov_b64 exec, -1
    v_exp_f32 v32, v32
    v_exp_f32 v33, v33
    v_exp_f32 v34, v34
    v_exp_f32 v35, v35
    v_exp_f32 v36, v36
    v_smfmac_f32_32x32x32_bf16 v[64:79], v[144:147], v[24:31], v195
    ds_read_b64_tr_b16 v[144:145], v193 offset:63440
    ds_read_b64_tr_b16 v[146:147], v194 offset:63440
    v_exp_f32 v37, v37
    v_exp_f32 v38, v38
    v_exp_f32 v39, v39
    v_exp_f32 v40, v40
    v_exp_f32 v41, v41
    v_exp_f32 v42, v42
    s_waitcnt lgkmcnt(7)
    v_smfmac_f32_32x32x32_bf16 v[64:79], v[140:143], v[32:39], v195
    ds_read_b64_tr_b16 v[140:141], v191 offset:64480
    ds_read_b64_tr_b16 v[142:143], v192 offset:64480
    v_exp_f32 v43, v43
    v_exp_f32 v44, v44
    v_exp_f32 v45, v45
    v_exp_f32 v46, v46
    v_exp_f32 v47, v47
    s_setprio 0
    s_waitcnt lgkmcnt(2)
    v_mfma_f32_32x32x16_bf16 v[16:31], v[136:139], v[128:131], v[96:111]
    v_exp_f32 v48, v48
    v_exp_f32 v49, v49
    v_exp_f32 v50, v50
    v_exp_f32 v51, v51
    v_exp_f32 v52, v52
    v_smfmac_f32_32x32x32_bf16 v[64:79], v[144:147], v[40:47], v195
    ds_read_b64_tr_b16 v[144:145], v193 offset:64480
    ds_read_b64_tr_b16 v[146:147], v194 offset:64480
    v_exp_f32 v53, v53
    v_exp_f32 v54, v54
    v_exp_f32 v55, v55
    v_exp_f32 v56, v56
    v_exp_f32 v57, v57
    v_exp_f32 v58, v58
    s_waitcnt lgkmcnt(2)
    v_smfmac_f32_32x32x32_bf16 v[64:79], v[140:143], v[48:55], v195
    ds_read_b64_tr_b16 v[140:141], v191 offset:65520
    ds_read_b64_tr_b16 v[142:143], v192 offset:65520
    ds_read_b32 v12, v199 offset:8
    v_exp_f32 v59, v59
    v_exp_f32 v60, v60
    v_exp_f32 v61, v61
    v_exp_f32 v62, v62
    v_exp_f32 v63, v63
    s_waitcnt lgkmcnt(0)
    v_cmp_ne_u32 vcc, 1, v12
    s_cbranch_vccnz L_wdn
L_rdn:
    ds_read_b128 v[172:175], v196 offset:0
    ds_read_b128 v[176:179], v196 offset:1024
    ds_read_b32 v180, v197 offset:2048
    v_exp_f32 v16, v16
    v_exp_f32 v17, v17
    v_exp_f32 v18, v18
    v_exp_f32 v19, v19
    v_exp_f32 v20, v20
    v_smfmac_f32_32x32x32_bf16 v[64:79], v[144:147], v[56:63], v195
    ds_read_b64_tr_b16 v[144:145], v193 offset:65520
    ds_read_b64_tr_b16 v[146:147], v194 offset:65520
    v_exp_f32 v21, v21
    v_exp_f32 v22, v22
    v_exp_f32 v23, v23
    v_exp_f32 v24, v24
    v_exp_f32 v25, v25
    v_exp_f32 v26, v26
    v_smfmac_f32_32x32x32_bf16 v[64:79], v[140:143], v[16:23], v195
    v_exp_f32 v27, v27
    v_exp_f32 v28, v28
    v_exp_f32 v29, v29
    v_exp_f32 v30, v30
    v_exp_f32 v31, v31
    s_waitcnt lgkmcnt(0)
    s_nop 1
    v_smfmac_f32_32x32x32_bf16 v[64:79], v[144:147], v[24:31], v195
L_finish:
    s_nop 11
    v_add_f32 v72, v72, v180
    v_add_f32 v64, v64, v172
    v_add_f32 v65, v65, v173
    v_add_f32 v66, v66, v174
    v_add_f32 v67, v67, v175
    v_add_f32 v68, v68, v176
    v_add_f32 v69, v69, v177
    v_add_f32 v70, v70, v178
    v_add_f32 v71, v71, v179
    v_rcp_f32 v32, v72
    v_max3_f32 v34, |v64|, |v65|, |v66|
    v_mul_f32 v48, v64, v32
    v_mul_f32 v49, v65, v32
    v_mul_f32 v50, v66, v32
    v_mul_f32 v51, v67, v32
    v_mul_f32 v52, v68, v32
    v_mul_f32 v53, v69, v32
    v_mul_f32 v54, v70, v32
    v_mul_f32 v55, v71, v32
    v_cvt_pk_bf16_f32 v148, v48, v49
    v_cvt_pk_bf16_f32 v149, v50, v51
    v_cvt_pk_bf16_f32 v150, v52, v53
    v_cvt_pk_bf16_f32 v151, v54, v55
    s_nop 1
    v_permlane32_swap_b32 v148, v150
    v_permlane32_swap_b32 v149, v151
    buffer_store_dwordx4 v[148:151], v2, s[16:19], s26 offen sc0 sc1
L_check:
    v_max3_f32 v35, |v67|, |v68|, |v69|
    v_max3_f32 v34, |v70|, |v71|, v34
    v_add_f32 v36, v64, v65
    v_add_f32 v37, v66, v67
    v_add_f32 v38, v68, v69
    v_add_f32 v39, v70, v71
    v_max_f32 v34, v34, v35
    v_add_f32 v36, v36, v37
    v_add_f32 v38, v38, v39
    v_add_f32 v36, v36, v38
    v_cmp_nle_f32 s[36:37], v72, s33
    v_cmp_nge_f32 s[38:39], v72, s34
    v_cmp_nle_f32 s[40:41], v34, s35
    v_cmp_u_f32 s[42:43], v36, v36
    s_nop 1
    s_or_b64 s[36:37], s[36:37], s[38:39]
    s_or_b64 s[40:41], s[40:41], s[42:43]
    s_or_b64 s[36:37], s[36:37], s[40:41]
    s_cbranch_scc1 L_fallback
L_end:
    s_endpgm
L_wf1:
    ds_read_b32 v12, v182 offset:64
    s_waitcnt lgkmcnt(0)
    v_cmp_ne_u32 vcc, 4, v12
    s_cbranch_vccnz L_wf1
    s_branch L_rf1
L_wg1:
    ds_read_b32 v12, v10 offset:4
    s_waitcnt lgkmcnt(0)
    v_cmp_ne_u32 vcc, 4, v12
    s_cbranch_vccnz L_wg1
    s_branch L_rg1
L_wxp:
    ds_read_b32 v12, v181 offset:0
    s_waitcnt lgkmcnt(0)
    v_cmp_ne_u32 vcc, 1, v12
    s_cbranch_vccnz L_wxp
    s_branch L_rxp
L_wg2:
    ds_read_b32 v12, v10 offset:8
    s_waitcnt lgkmcnt(0)
    v_cmp_ne_u32 vcc, 4, v12
    s_cbranch_vccnz L_wg2
    s_branch L_rg2
L_wg3:
    ds_read_b32 v12, v10 offset:12
    s_waitcnt lgkmcnt(0)
    v_cmp_ne_u32 vcc, 4, v12
    s_cbranch_vccnz L_wg3
    s_branch L_rg3
L_wg4:
    ds_read_b32 v12, v10 offset:16
    s_waitcnt lgkmcnt(0)
    v_cmp_ne_u32 vcc, 4, v12
    s_cbranch_vccnz L_wg4
    s_branch L_rg4
L_wg5:
    ds_read_b32 v12, v10 offset:20
    s_waitcnt lgkmcnt(0)
    v_cmp_ne_u32 vcc, 4, v12
    s_cbranch_vccnz L_wg5
    s_branch L_rg5
L_wfin:
    ds_read_b32 v12, v200 offset:0
    s_waitcnt lgkmcnt(0)
    v_cmp_ne_u32 vcc, 8, v12
    s_cbranch_vccnz L_wfin
    s_branch L_rfin
L_wdn:
    ds_read_b32 v12, v199 offset:8
    s_waitcnt lgkmcnt(0)
    v_cmp_ne_u32 vcc, 1, v12
    s_cbranch_vccnz L_wdn
    s_branch L_rdn
L_fallback:
    v_mov_b32 v161, 0xff800000
    v_mov_b32 v156, v190
    s_mov_b32 s32, 64
L_fb_max0:
    ds_read_b128 v[136:139], v156
    v_add_u32 v156, 1024, v156
    s_waitcnt lgkmcnt(0)
    v_mfma_f32_32x32x16_bf16 v[16:31], v[136:139], v[128:131], 0
    s_nop 15
    v_max3_f32 v161, v161, v16, v17
    v_max3_f32 v161, v161, v18, v19
    v_max3_f32 v161, v161, v20, v21
    v_max3_f32 v161, v161, v22, v23
    v_max3_f32 v161, v161, v24, v25
    v_max3_f32 v161, v161, v26, v27
    v_max3_f32 v161, v161, v28, v29
    v_max3_f32 v161, v161, v30, v31
    s_sub_u32 s32, s32, 1
    s_cmp_lg_u32 s32, 0
    s_cbranch_scc1 L_fb_max0
    v_mov_b32 v162, v161
    s_nop 1
    v_permlane32_swap_b32 v161, v162
    s_nop 1
    v_max_f32 v161, v161, v162
    v_mov_b32 v64, 0
    v_mov_b32 v65, 0
    v_mov_b32 v66, 0
    v_mov_b32 v67, 0
    v_mov_b32 v68, 0
    v_mov_b32 v69, 0
    v_mov_b32 v70, 0
    v_mov_b32 v71, 0
    v_mov_b32 v72, 0
    v_mov_b32 v73, 0
    v_mov_b32 v74, 0
    v_mov_b32 v75, 0
    v_mov_b32 v76, 0
    v_mov_b32 v77, 0
    v_mov_b32 v78, 0
    v_mov_b32 v79, 0
    v_mov_b32 v156, v190
    v_mov_b32 v157, v191
    v_mov_b32 v158, v192
    v_mov_b32 v159, v193
    v_mov_b32 v160, v194
    s_mov_b32 s32, 64
L_fb_acc0:
    ds_read_b128 v[136:139], v156
    ds_read_b64_tr_b16 v[140:141], v157
    ds_read_b64_tr_b16 v[142:143], v158
    ds_read_b64_tr_b16 v[144:145], v159
    ds_read_b64_tr_b16 v[146:147], v160
    v_add_u32 v156, 1024, v156
    v_add_u32 v157, 1040, v157
    v_add_u32 v158, 1040, v158
    v_add_u32 v159, 1040, v159
    v_add_u32 v160, 1040, v160
    s_waitcnt lgkmcnt(0)
    v_mfma_f32_32x32x16_bf16 v[16:31], v[136:139], v[128:131], 0
    s_nop 15
    v_sub_f32 v16, v16, v161
    v_sub_f32 v17, v17, v161
    v_sub_f32 v18, v18, v161
    v_sub_f32 v19, v19, v161
    v_sub_f32 v20, v20, v161
    v_sub_f32 v21, v21, v161
    v_sub_f32 v22, v22, v161
    v_sub_f32 v23, v23, v161
    v_sub_f32 v24, v24, v161
    v_sub_f32 v25, v25, v161
    v_sub_f32 v26, v26, v161
    v_sub_f32 v27, v27, v161
    v_sub_f32 v28, v28, v161
    v_sub_f32 v29, v29, v161
    v_sub_f32 v30, v30, v161
    v_sub_f32 v31, v31, v161
    v_exp_f32 v16, v16
    v_exp_f32 v17, v17
    v_exp_f32 v18, v18
    v_exp_f32 v19, v19
    v_exp_f32 v20, v20
    v_exp_f32 v21, v21
    v_exp_f32 v22, v22
    v_exp_f32 v23, v23
    v_exp_f32 v24, v24
    v_exp_f32 v25, v25
    v_exp_f32 v26, v26
    v_exp_f32 v27, v27
    v_exp_f32 v28, v28
    v_exp_f32 v29, v29
    v_exp_f32 v30, v30
    v_exp_f32 v31, v31
    s_nop 3
    v_smfmac_f32_32x32x32_bf16 v[64:79], v[140:143], v[16:23], v195
    v_smfmac_f32_32x32x32_bf16 v[64:79], v[144:147], v[24:31], v195
    s_sub_u32 s32, s32, 1
    s_cmp_lg_u32 s32, 0
    s_cbranch_scc1 L_fb_acc0
    s_nop 15
    s_waitcnt vmcnt(0)
    v_rcp_f32 v32, v72
    v_max3_f32 v34, |v64|, |v65|, |v66|
    v_mul_f32 v48, v64, v32
    v_mul_f32 v49, v65, v32
    v_mul_f32 v50, v66, v32
    v_mul_f32 v51, v67, v32
    v_mul_f32 v52, v68, v32
    v_mul_f32 v53, v69, v32
    v_mul_f32 v54, v70, v32
    v_mul_f32 v55, v71, v32
    v_cvt_pk_bf16_f32 v148, v48, v49
    v_cvt_pk_bf16_f32 v149, v50, v51
    v_cvt_pk_bf16_f32 v150, v52, v53
    v_cvt_pk_bf16_f32 v151, v54, v55
    s_nop 1
    v_permlane32_swap_b32 v148, v150
    v_permlane32_swap_b32 v149, v151
    buffer_store_dwordx4 v[148:151], v2, s[16:19], s26 offen sc0 sc1
    s_endpgm
.section .rodata,"a"
.p2align 6
.amdhsa_kernel standalone__fused_io_aware_attn__prompt_kernel
  .amdhsa_next_free_vgpr 208
  .amdhsa_next_free_sgpr 48
  .amdhsa_accum_offset 208
  .amdhsa_group_segment_fixed_size 0
  .amdhsa_kernarg_size 48
  .amdhsa_user_sgpr_count 2
  .amdhsa_user_sgpr_kernarg_segment_ptr 1
  .amdhsa_system_sgpr_workgroup_id_x 1
.end_amdhsa_kernel
```
